```python
import torch

def _softmax(x, axis=-1):
    return torch.softmax(x, dim=axis)
def _gelu(x):
    return torch.nn.functional.gelu(x, approximate="tanh")
def _silu(x):
    return torch.nn.functional.silu(x)
def _sigmoid(x):
    return torch.sigmoid(x)
def _layernorm(x, axis=-1, eps=1e-5):
    m = x.mean(dim=axis, keepdim=True)
    v = x.var(dim=axis, keepdim=True, unbiased=False)
    return (x - m) / torch.sqrt(v + eps)
def _scatter_add(tgt, idx, src, axis=0):
    return tgt.clone().index_add_(axis, idx, src)
def _segment_sum(src, seg, n):
    out = torch.zeros((n,) + src.shape[1:], dtype=src.dtype)
    return out.index_add_(0, seg, src)
def _pad(x, pw):
    flat = tuple(v for pair in reversed(pw) for v in pair)
    return torch.nn.functional.pad(x, flat)

kernel_name = 'standalone__fft_conv__vision'

def setup_inputs():

    _w = (lambda a: (lambda t: t.to(torch.bfloat16) if t.is_floating_point() else t)(torch.as_tensor(a)))
    H = W = 224
    C = 96
    K = 3
    return {
        "x": _w((lambda *s: torch.randn(*s, dtype=torch.bfloat16) * 0.05)(1, H, W, C)),
        "w": _w((lambda *s: torch.randn(*s, dtype=torch.bfloat16) * 0.05)(K, K, C, C)),
    }

def reference(x, w):
    B, H, W, C = x.shape
    K = w.shape[0]
    wp = _pad(w, ((0, H - K), (0, W - K), (0, 0), (0, 0)))
    Xf = (lambda x, axes=(-2,-1): torch.fft.rfft2(x.float(), dim=axes))(x, axes=(1, 2))
    Wf = (lambda x, axes=(-2,-1): torch.fft.rfft2(x.float(), dim=axes))(wp, axes=(0, 1))
    Yf = torch.einsum('bhwi,hwio->bhwo', Xf, Wf)
    y = (lambda x, s, axes=(-2,-1): torch.fft.irfft2(x, s=s, dim=axes).to(torch.bfloat16))(Yf, (H, W), axes=(1, 2))
    return y
```

```asm
; @launch grid=(224,1,1) block=(256,1,1) lds=163840
.amdgcn_target "amdgcn-amd-amdhsa--gfx950"
.text
.globl standalone__fft_conv__vision_kernel
.p2align 8
.type standalone__fft_conv__vision_kernel,@function
standalone__fft_conv__vision_kernel:
    s_load_dwordx2 s[8:9], s[0:1], 0
    s_load_dwordx2 s[12:13], s[0:1], 8
    s_cmpk_ge_u32 s2, 224
    s_cbranch_scc1 L_end
    s_getpc_b64 s[88:89]
L_pc:
    v_mul_u32_u24 v22, 44, v0
    global_load_dword v23, v22, s[88:89]
    v_readfirstlane_b32 s3, v0
    s_lshr_b32 s45, s2, 3
    s_and_b32 s43, s2, 7
    s_cmp_ge_u32 s45, 14
    s_cselect_b32 s44, 14, 0
    s_sub_u32 s47, s45, s44
    s_mul_i32 s46, s43, 28
    s_add_u32 s46, s46, s44
    s_mulk_i32 s47, 3072
    s_addk_i32 s47, -384
    s_lshl_b32 s40, s3, 4
    v_lshrrev_b32 v17, 4, v0
    v_mul_u32_u24 v17, 43, v17
    v_lshrrev_b32 v17, 6, v17
    v_and_b32 v17, 2, v17
    v_xor_b32 v16, v0, v17
    v_lshl_add_u32 v16, v16, 4, s47
    v_add_u32 v17, 43008, v16
    v_min_u32 v10, v16, v17
    s_mul_i32 s26, s46, 43008
    s_mov_b32 s10, 9633792
    s_mov_b32 s11, 0x20000
    s_mulk_i32 s45, 47*128
    s_mul_i32 s44, s3, 24
    s_add_u32 s45, s45, s44
    v_and_b32 v21, 63, v0
    v_min_u32 v21, 11, v21
    v_lshl_add_u32 v21, v21, 7, s45
    s_mov_b32 s14, 165888
    s_mov_b32 s15, s11
    s_waitcnt lgkmcnt(0)
    s_add_u32 m0, s40, 61440
    s_add_u32 s39, s26, 559104
    buffer_load_dwordx4 v10, s[8:11], s39 offen lds
    s_add_u32 m0, s40, 32768
    s_add_u32 s32, s26, 258048
    buffer_load_dwordx4 v10, s[8:11], s32 offen lds
    s_add_u32 m0, s40, 57344
    s_add_u32 s38, s26, 516096
    buffer_load_dwordx4 v10, s[8:11], s38 offen lds
    s_add_u32 m0, s40, 28672
    s_add_u32 s31, s26, 215040
    buffer_load_dwordx4 v10, s[8:11], s31 offen lds
    buffer_load_dword v23, v21, s[12:15], 0 offen
    s_load_dwordx2 s[16:17], s[0:1], 16
    v_and_b32 v0, 63, v0
    v_lshlrev_b32 v16, 4, v0
    v_and_b32 v17, 32, v0
    s_mul_i32 s44, s3, 48
    s_add_u32 s41, s44, 65536
    v_add_u32 v11, s44, v16
    v_xor_b32 v13, 32, v11
    v_xor_b32 v12, v17, v11
    s_add_u32 m0, s41, 0
    s_nop 0
    buffer_load_dwordx4 v11, s[12:15], 0 offen offset:0 lds
    buffer_load_dwordx4 v12, s[12:15], 0 offen offset:1024 lds
    buffer_load_dwordx4 v13, s[12:15], 0 offen offset:2048 lds
    s_add_u32 m0, s41, 12288
    s_mov_b32 s65, 12288
    buffer_load_dwordx4 v11, s[12:15], s65 offen offset:0 lds
    buffer_load_dwordx4 v12, s[12:15], s65 offen offset:1024 lds
    buffer_load_dwordx4 v13, s[12:15], s65 offen offset:2048 lds
    s_add_u32 m0, s41, 24576
    s_mov_b32 s66, 24576
    buffer_load_dwordx4 v11, s[12:15], s66 offen offset:0 lds
    buffer_load_dwordx4 v12, s[12:15], s66 offen offset:1024 lds
    buffer_load_dwordx4 v13, s[12:15], s66 offen offset:2048 lds
    s_add_u32 m0, s41, 36864
    s_mov_b32 s67, 36864
    buffer_load_dwordx4 v11, s[12:15], s67 offen offset:0 lds
    buffer_load_dwordx4 v12, s[12:15], s67 offen offset:1024 lds
    buffer_load_dwordx4 v13, s[12:15], s67 offen offset:2048 lds
    s_add_u32 m0, s40, 53248
    s_add_u32 s37, s26, 473088
    buffer_load_dwordx4 v10, s[8:11], s37 offen lds
    s_add_u32 m0, s40, 24576
    s_add_u32 s30, s26, 172032
    buffer_load_dwordx4 v10, s[8:11], s30 offen lds
    s_add_u32 m0, s41, 49152
    s_mov_b32 s68, 49152
    buffer_load_dwordx4 v11, s[12:15], s68 offen offset:0 lds
    buffer_load_dwordx4 v12, s[12:15], s68 offen offset:1024 lds
    buffer_load_dwordx4 v13, s[12:15], s68 offen offset:2048 lds
    s_add_u32 m0, s41, 61440
    s_mov_b32 s69, 61440
    buffer_load_dwordx4 v11, s[12:15], s69 offen offset:0 lds
    buffer_load_dwordx4 v12, s[12:15], s69 offen offset:1024 lds
    buffer_load_dwordx4 v13, s[12:15], s69 offen offset:2048 lds
    s_add_u32 m0, s41, 73728
    s_mov_b32 s70, 73728
    buffer_load_dwordx4 v11, s[12:15], s70 offen offset:0 lds
    buffer_load_dwordx4 v12, s[12:15], s70 offen offset:1024 lds
    buffer_load_dwordx4 v13, s[12:15], s70 offen offset:2048 lds
    s_mov_b32 s71, 86016
    s_mov_b32 s72, 98304
    s_mov_b32 s73, 110592
    s_mov_b32 s74, 122880
    s_mov_b32 s75, 135168
    s_mov_b32 s76, 147456
    s_mov_b32 s77, 159744
    s_add_u32 s27, s26, 43008
    s_add_u32 s28, s26, 86016
    s_add_u32 s29, s26, 129024
    s_add_u32 s33, s26, 301056
    s_add_u32 s34, s26, 344064
    s_add_u32 s35, s26, 387072
    s_add_u32 s36, s26, 430080
    s_add_u32 s45, s46, 222
    s_cmp_ge_u32 s45, 224
    s_cselect_b32 s44, 224, 0
    s_sub_u32 s45, s45, s44
    s_mul_i32 s24, s45, 43008
    s_add_u32 s25, s24, 43008
    s_mov_b32 s18, s10
    s_mov_b32 s19, s11
    s_lshr_b32 s3, s3, 6
    s_addk_i32 s47, 384
    v_and_b32 v16, 15, v0
    v_lshrrev_b32 v17, 4, v0
    s_lshr_b32 s86, s3, 1
    s_and_b32 s45, s3, 1
    s_xor_b32 s43, s86, 1
    s_mul_i32 s87, s43, 7
    s_mul_i32 s43, s87, 4096
    v_add_u32 v18, 2, v16
    v_lshrrev_b32 v19, 1, v18
    v_and_b32 v19, 2, v19
    v_xor_b32 v19, v19, v17
    v_mul_u32_u24 v18, 192, v18
    v_lshl_add_u32 v18, v19, 4, v18
    v_add_u32 v1, s43, v18
    v_add_u32 v18, 1, v16
    v_lshrrev_b32 v19, 1, v18
    v_and_b32 v19, 2, v19
    v_xor_b32 v19, v19, v17
    v_mul_u32_u24 v18, 192, v18
    v_lshl_add_u32 v18, v19, 4, v18
    v_add_u32 v2, s43, v18
    v_add_u32 v18, 0, v16
    v_lshrrev_b32 v19, 1, v18
    v_and_b32 v19, 2, v19
    v_xor_b32 v19, v19, v17
    v_mul_u32_u24 v18, 192, v18
    v_lshl_add_u32 v18, v19, 4, v18
    v_add_u32 v3, s43, v18
    v_lshrrev_b32 v18, 2, v16
    v_lshl_add_u32 v18, v17, 3, v18
    v_mul_u32_u24 v18, 192, v18
    v_add_u32 v18, 65536, v18
    v_and_b32 v19, 3, v0
    v_and_b32 v20, 1, v17
    v_lshlrev_b32 v20, 5, v20
    s_lshl_b32 s43, s45, 7
    s_lshl_b32 s44, s45, 5
    s_add_u32 s44, s44, 64
    v_lshlrev_b32 v19, 3, v19
    v_add3_u32 v21, v19, 0, s43
    v_xor_b32 v21, v21, v20
    v_add_u32 v4, v21, v18
    v_add_u32 v7, 61440, v4
    v_add3_u32 v21, v19, 32, s43
    v_xor_b32 v21, v21, v20
    v_add_u32 v5, v21, v18
    v_add_u32 v8, 61440, v5
    v_add_u32 v21, s44, v19
    v_xor_b32 v21, v21, v20
    v_add_u32 v6, v21, v18
    v_add_u32 v9, 61440, v6
    v_mul_u32_u24 v18, 192, v16
    v_lshrrev_b32 v19, 1, v17
    v_lshl_add_u32 v19, v19, 4, v20
    v_add3_u32 v14, v18, v19, s43
    v_lshl_add_u32 v18, v17, 3, v18
    v_add_u32 v15, s44, v18
    v_and_b32 v21, 14, v16
    v_add_u32 v21, s45, v21
    v_and_b32 v22, 1, v16
    v_mul_u32_u24 v18, 192, v21
    v_lshl_add_u32 v18, v22, 5, v18
    v_lshl_add_u32 v18, v17, 3, v18
    v_add_u32 v18, 64, v18
    s_mul_i32 s43, s86, 1040
    s_add_u32 s43, s43, 139264
    v_lshl_add_u32 v21, v17, 4, v21
    v_mul_u32_u24 v22, 520, v22
    v_lshl_add_u32 v21, v21, 3, v22
    v_add_u32 v19, s43, v21
    s_mul_i32 s44, s45, 520
    s_add_u32 s43, s43, s44
    v_lshl_add_u32 v20, v0, 3, s43
    s_add_u32 s43, s46, s87
    s_mul_i32 s43, s43, 43008
    s_add_u32 s42, s43, s47
    s_waitcnt lgkmcnt(0)
    s_waitcnt vmcnt(17)
    s_barrier
    ds_read_b128 v[84:87], v1 offset:28672
    ds_read_b128 v[88:91], v1 offset:32768
    ds_read_b64_tr_b16 a[0:1], v4 offset:0
    ds_read_b64_tr_b16 a[2:3], v4 offset:768
    ds_read_b64_tr_b16 a[4:5], v5 offset:0
    ds_read_b64_tr_b16 a[6:7], v5 offset:768
    ds_read_b64_tr_b16 a[8:9], v6 offset:0
    ds_read_b64_tr_b16 a[10:11], v6 offset:768
    ds_read_b128 v[92:95], v1 offset:28736
    ds_read_b128 v[96:99], v1 offset:32832
    ds_read_b64_tr_b16 a[12:13], v4 offset:6144
    ds_read_b64_tr_b16 a[14:15], v4 offset:6912
    ds_read_b64_tr_b16 a[16:17], v5 offset:6144
    ds_read_b64_tr_b16 a[18:19], v5 offset:6912
    ds_read_b64_tr_b16 a[20:21], v6 offset:6144
    ds_read_b64_tr_b16 a[22:23], v6 offset:6912
    ds_read_b128 v[100:103], v1 offset:28800
    ds_read_b128 v[104:107], v1 offset:32896
    ds_read_b64_tr_b16 a[24:25], v4 offset:12288
    ds_read_b64_tr_b16 a[26:27], v4 offset:13056
    ds_read_b64_tr_b16 a[28:29], v5 offset:12288
    ds_read_b64_tr_b16 a[30:31], v5 offset:13056
    ds_read_b64_tr_b16 a[32:33], v6 offset:12288
    ds_read_b64_tr_b16 a[34:35], v6 offset:13056
    s_waitcnt lgkmcnt(15)
    v_mfma_f32_16x16x32_bf16 v[36:39], a[0:3], v[84:87], 0
    ds_read_b128 v[108:111], v2 offset:28672
    ds_read_b128 v[112:115], v2 offset:32768
    v_mfma_f32_16x16x32_bf16 v[40:43], a[4:7], v[84:87], 0
    ds_read_b64_tr_b16 a[36:37], v4 offset:18432
    ds_read_b64_tr_b16 a[38:39], v4 offset:19200
    v_mfma_f32_16x16x32_bf16 v[44:47], a[8:11], v[84:87], 0
    ds_read_b64_tr_b16 a[40:41], v5 offset:18432
    ds_read_b64_tr_b16 a[42:43], v5 offset:19200
    v_mfma_f32_16x16x32_bf16 v[24:27], a[0:3], v[88:91], 0
    ds_read_b64_tr_b16 a[44:45], v6 offset:18432
    ds_read_b64_tr_b16 a[46:47], v6 offset:19200
    v_mfma_f32_16x16x32_bf16 v[28:31], a[4:7], v[88:91], 0
    s_add_u32 m0, s41, 86016
    v_mfma_f32_16x16x32_bf16 v[32:35], a[8:11], v[88:91], 0
    buffer_load_dwordx4 v11, s[12:15], s71 offen offset:0 lds
    s_waitcnt vmcnt(15) lgkmcnt(15)
    s_barrier
    v_mfma_f32_16x16x32_bf16 v[36:39], a[12:15], v[92:95], v[36:39]
    ds_read_b128 v[84:87], v2 offset:28736
    ds_read_b128 v[88:91], v2 offset:32832
    v_mfma_f32_16x16x32_bf16 v[40:43], a[16:19], v[92:95], v[40:43]
    ds_read_b64_tr_b16 a[48:49], v4 offset:24576
    ds_read_b64_tr_b16 a[50:51], v4 offset:25344
    v_mfma_f32_16x16x32_bf16 v[44:47], a[20:23], v[92:95], v[44:47]
    ds_read_b64_tr_b16 a[52:53], v5 offset:24576
    ds_read_b64_tr_b16 a[54:55], v5 offset:25344
    v_mfma_f32_16x16x32_bf16 v[24:27], a[12:15], v[96:99], v[24:27]
    ds_read_b64_tr_b16 a[56:57], v6 offset:24576
    ds_read_b64_tr_b16 a[58:59], v6 offset:25344
    v_mfma_f32_16x16x32_bf16 v[28:31], a[16:19], v[96:99], v[28:31]
    buffer_load_dwordx4 v12, s[12:15], s71 offen offset:1024 lds
    v_mfma_f32_16x16x32_bf16 v[32:35], a[20:23], v[96:99], v[32:35]
    buffer_load_dwordx4 v13, s[12:15], s71 offen offset:2048 lds
    s_waitcnt lgkmcnt(15)
    v_mfma_f32_16x16x32_bf16 v[36:39], a[24:27], v[100:103], v[36:39]
    ds_read_b128 v[92:95], v2 offset:28800
    ds_read_b128 v[96:99], v2 offset:32896
    v_mfma_f32_16x16x32_bf16 v[40:43], a[28:31], v[100:103], v[40:43]
    ds_read_b64_tr_b16 a[60:61], v4 offset:30720
    ds_read_b64_tr_b16 a[62:63], v4 offset:31488
    v_mfma_f32_16x16x32_bf16 v[44:47], a[32:35], v[100:103], v[44:47]
    ds_read_b64_tr_b16 a[64:65], v5 offset:30720
    ds_read_b64_tr_b16 a[66:67], v5 offset:31488
    v_mfma_f32_16x16x32_bf16 v[24:27], a[24:27], v[104:107], v[24:27]
    ds_read_b64_tr_b16 a[68:69], v6 offset:30720
    ds_read_b64_tr_b16 a[70:71], v6 offset:31488
    v_mfma_f32_16x16x32_bf16 v[28:31], a[28:31], v[104:107], v[28:31]
    s_add_u32 m0, s40, 49152
    v_mfma_f32_16x16x32_bf16 v[32:35], a[32:35], v[104:107], v[32:35]
    buffer_load_dwordx4 v10, s[8:11], s36 offen lds
    s_waitcnt vmcnt(15) lgkmcnt(15)
    s_barrier
    v_mfma_f32_16x16x32_bf16 v[36:39], a[36:39], v[108:111], v[36:39]
    ds_read_b128 v[100:103], v3 offset:28672
    ds_read_b128 v[104:107], v3 offset:32768
    v_mfma_f32_16x16x32_bf16 v[40:43], a[40:43], v[108:111], v[40:43]
    ds_read_b64_tr_b16 a[72:73], v4 offset:36864
    ds_read_b64_tr_b16 a[74:75], v4 offset:37632
    v_mfma_f32_16x16x32_bf16 v[44:47], a[44:47], v[108:111], v[44:47]
    ds_read_b64_tr_b16 a[76:77], v5 offset:36864
    ds_read_b64_tr_b16 a[78:79], v5 offset:37632
    v_mfma_f32_16x16x32_bf16 v[24:27], a[36:39], v[112:115], v[24:27]
    ds_read_b64_tr_b16 a[80:81], v6 offset:36864
    ds_read_b64_tr_b16 a[82:83], v6 offset:37632
    v_mfma_f32_16x16x32_bf16 v[28:31], a[40:43], v[112:115], v[28:31]
    s_add_u32 m0, s40, 20480
    v_mfma_f32_16x16x32_bf16 v[32:35], a[44:47], v[112:115], v[32:35]
    buffer_load_dwordx4 v10, s[8:11], s29 offen lds
    s_waitcnt lgkmcnt(15)
    v_mfma_f32_16x16x32_bf16 v[36:39], a[48:51], v[84:87], v[36:39]
    ds_read_b128 v[108:111], v3 offset:28736
    ds_read_b128 v[112:115], v3 offset:32832
    v_mfma_f32_16x16x32_bf16 v[40:43], a[52:55], v[84:87], v[40:43]
    ds_read_b64_tr_b16 a[84:85], v4 offset:43008
    ds_read_b64_tr_b16 a[86:87], v4 offset:43776
    v_mfma_f32_16x16x32_bf16 v[44:47], a[56:59], v[84:87], v[44:47]
    ds_read_b64_tr_b16 a[88:89], v5 offset:43008
    ds_read_b64_tr_b16 a[90:91], v5 offset:43776
    v_mfma_f32_16x16x32_bf16 v[24:27], a[48:51], v[88:91], v[24:27]
    ds_read_b64_tr_b16 a[92:93], v6 offset:43008
    ds_read_b64_tr_b16 a[94:95], v6 offset:43776
    v_mfma_f32_16x16x32_bf16 v[28:31], a[52:55], v[88:91], v[28:31]
    s_add_u32 m0, s41, 0
    v_mfma_f32_16x16x32_bf16 v[32:35], a[56:59], v[88:91], v[32:35]
    buffer_load_dwordx4 v11, s[12:15], s72 offen offset:0 lds
    s_waitcnt vmcnt(12) lgkmcnt(15)
    s_barrier
    v_mfma_f32_16x16x32_bf16 v[36:39], a[60:63], v[92:95], v[36:39]
    ds_read_b128 v[84:87], v3 offset:28800
    ds_read_b128 v[88:91], v3 offset:32896
    v_mfma_f32_16x16x32_bf16 v[40:43], a[64:67], v[92:95], v[40:43]
    ds_read_b64_tr_b16 a[96:97], v4 offset:49152
    ds_read_b64_tr_b16 a[98:99], v4 offset:49920
    v_mfma_f32_16x16x32_bf16 v[44:47], a[68:71], v[92:95], v[44:47]
    ds_read_b64_tr_b16 a[100:101], v5 offset:49152
    ds_read_b64_tr_b16 a[102:103], v5 offset:49920
    v_mfma_f32_16x16x32_bf16 v[24:27], a[60:63], v[96:99], v[24:27]
    ds_read_b64_tr_b16 a[104:105], v6 offset:49152
    ds_read_b64_tr_b16 a[106:107], v6 offset:49920
    v_mfma_f32_16x16x32_bf16 v[28:31], a[64:67], v[96:99], v[28:31]
    buffer_load_dwordx4 v12, s[12:15], s72 offen offset:1024 lds
    v_mfma_f32_16x16x32_bf16 v[32:35], a[68:71], v[96:99], v[32:35]
    buffer_load_dwordx4 v13, s[12:15], s72 offen offset:2048 lds
    s_waitcnt lgkmcnt(15)
    v_mfma_f32_16x16x32_bf16 v[36:39], a[72:75], v[100:103], v[36:39]
    ds_read_b128 v[92:95], v1 offset:24576
    ds_read_b128 v[96:99], v1 offset:28672
    v_mfma_f32_16x16x32_bf16 v[40:43], a[76:79], v[100:103], v[40:43]
    ds_read_b64_tr_b16 a[108:109], v4 offset:55296
    ds_read_b64_tr_b16 a[110:111], v4 offset:56064
    v_mfma_f32_16x16x32_bf16 v[44:47], a[80:83], v[100:103], v[44:47]
    ds_read_b64_tr_b16 a[112:113], v5 offset:55296
    ds_read_b64_tr_b16 a[114:115], v5 offset:56064
    v_mfma_f32_16x16x32_bf16 v[24:27], a[72:75], v[104:107], v[24:27]
    ds_read_b64_tr_b16 a[116:117], v6 offset:55296
    ds_read_b64_tr_b16 a[118:119], v6 offset:56064
    v_mfma_f32_16x16x32_bf16 v[28:31], a[76:79], v[104:107], v[28:31]
    s_add_u32 m0, s41, 12288
    v_mfma_f32_16x16x32_bf16 v[32:35], a[80:83], v[104:107], v[32:35]
    buffer_load_dwordx4 v11, s[12:15], s73 offen offset:0 lds
    s_waitcnt vmcnt(12) lgkmcnt(15)
    s_barrier
    v_mfma_f32_16x16x32_bf16 v[36:39], a[84:87], v[108:111], v[36:39]
    ds_read_b128 v[100:103], v1 offset:24640
    ds_read_b128 v[104:107], v1 offset:28736
    v_mfma_f32_16x16x32_bf16 v[40:43], a[88:91], v[108:111], v[40:43]
    ds_read_b64_tr_b16 a[120:121], v7 offset:0
    ds_read_b64_tr_b16 a[122:123], v7 offset:768
    v_mfma_f32_16x16x32_bf16 v[44:47], a[92:95], v[108:111], v[44:47]
    ds_read_b64_tr_b16 a[124:125], v8 offset:0
    ds_read_b64_tr_b16 a[126:127], v8 offset:768
    v_mfma_f32_16x16x32_bf16 v[24:27], a[84:87], v[112:115], v[24:27]
    ds_read_b64_tr_b16 a[128:129], v9 offset:0
    ds_read_b64_tr_b16 a[130:131], v9 offset:768
    v_mfma_f32_16x16x32_bf16 v[28:31], a[88:91], v[112:115], v[28:31]
    buffer_load_dwordx4 v12, s[12:15], s73 offen offset:1024 lds
    v_mfma_f32_16x16x32_bf16 v[32:35], a[92:95], v[112:115], v[32:35]
    buffer_load_dwordx4 v13, s[12:15], s73 offen offset:2048 lds
    s_waitcnt lgkmcnt(15)
    v_mfma_f32_16x16x32_bf16 v[36:39], a[96:99], v[84:87], v[36:39]
    ds_read_b128 v[108:111], v1 offset:24704
    ds_read_b128 v[112:115], v1 offset:28800
    v_mfma_f32_16x16x32_bf16 v[40:43], a[100:103], v[84:87], v[40:43]
    ds_read_b64_tr_b16 a[132:133], v7 offset:6144
    ds_read_b64_tr_b16 a[134:135], v7 offset:6912
    v_mfma_f32_16x16x32_bf16 v[44:47], a[104:107], v[84:87], v[44:47]
    ds_read_b64_tr_b16 a[136:137], v8 offset:6144
    ds_read_b64_tr_b16 a[138:139], v8 offset:6912
    v_mfma_f32_16x16x32_bf16 v[24:27], a[96:99], v[88:91], v[24:27]
    ds_read_b64_tr_b16 a[140:141], v9 offset:6144
    ds_read_b64_tr_b16 a[142:143], v9 offset:6912
    v_mfma_f32_16x16x32_bf16 v[28:31], a[100:103], v[88:91], v[28:31]
    s_add_u32 m0, s41, 24576
    v_mfma_f32_16x16x32_bf16 v[32:35], a[104:107], v[88:91], v[32:35]
    buffer_load_dwordx4 v11, s[12:15], s74 offen offset:0 lds
    s_waitcnt vmcnt(12) lgkmcnt(15)
    s_barrier
    v_mfma_f32_16x16x32_bf16 v[48:51], a[0:3], v[92:95], 0
    ds_read_b128 v[84:87], v2 offset:24576
    buffer_load_dwordx4 v12, s[12:15], s74 offen offset:1024 lds
    v_mfma_f32_16x16x32_bf16 v[52:55], a[4:7], v[92:95], 0
    ds_read_b128 v[88:91], v2 offset:28672
    v_mfma_f32_16x16x32_bf16 v[56:59], a[8:11], v[92:95], 0
    ds_read_b64_tr_b16 a[144:145], v7 offset:12288
    buffer_load_dwordx4 v13, s[12:15], s74 offen offset:2048 lds
    v_mfma_f32_16x16x32_bf16 v[36:39], a[108:111], v[92:95], v[36:39]
    ds_read_b64_tr_b16 a[146:147], v7 offset:13056
    v_mfma_f32_16x16x32_bf16 v[40:43], a[112:115], v[92:95], v[40:43]
    ds_read_b64_tr_b16 a[148:149], v8 offset:12288
    s_add_u32 m0, s41, 36864
    v_mfma_f32_16x16x32_bf16 v[44:47], a[116:119], v[92:95], v[44:47]
    ds_read_b64_tr_b16 a[150:151], v8 offset:13056
    buffer_load_dwordx4 v11, s[12:15], s75 offen offset:0 lds
    v_mfma_f32_16x16x32_bf16 v[24:27], a[108:111], v[96:99], v[24:27]
    ds_read_b64_tr_b16 a[152:153], v9 offset:12288
    v_mfma_f32_16x16x32_bf16 v[28:31], a[112:115], v[96:99], v[28:31]
    ds_read_b64_tr_b16 a[154:155], v9 offset:13056
    v_mfma_f32_16x16x32_bf16 v[32:35], a[116:119], v[96:99], v[32:35]
    s_waitcnt lgkmcnt(15)
    v_mfma_f32_16x16x32_bf16 v[48:51], a[12:15], v[100:103], v[48:51]
    ds_read_b128 v[92:95], v2 offset:24640
    buffer_load_dwordx4 v12, s[12:15], s75 offen offset:1024 lds
    v_mfma_f32_16x16x32_bf16 v[52:55], a[16:19], v[100:103], v[52:55]
    ds_read_b128 v[96:99], v2 offset:28736
    v_mfma_f32_16x16x32_bf16 v[56:59], a[20:23], v[100:103], v[56:59]
    ds_read_b64_tr_b16 a[156:157], v7 offset:18432
    buffer_load_dwordx4 v13, s[12:15], s75 offen offset:2048 lds
    v_mfma_f32_16x16x32_bf16 v[36:39], a[120:123], v[100:103], v[36:39]
    ds_read_b64_tr_b16 a[158:159], v7 offset:19200
    v_mfma_f32_16x16x32_bf16 v[40:43], a[124:127], v[100:103], v[40:43]
    ds_read_b64_tr_b16 a[160:161], v8 offset:18432
    v_mfma_f32_16x16x32_bf16 v[44:47], a[128:131], v[100:103], v[44:47]
    ds_read_b64_tr_b16 a[162:163], v8 offset:19200
    v_mfma_f32_16x16x32_bf16 v[24:27], a[120:123], v[104:107], v[24:27]
    ds_read_b64_tr_b16 a[164:165], v9 offset:18432
    v_mfma_f32_16x16x32_bf16 v[28:31], a[124:127], v[104:107], v[28:31]
    ds_read_b64_tr_b16 a[166:167], v9 offset:19200
    v_mfma_f32_16x16x32_bf16 v[32:35], a[128:131], v[104:107], v[32:35]
    s_waitcnt vmcnt(14) lgkmcnt(15)
    s_barrier
    v_mfma_f32_16x16x32_bf16 v[48:51], a[24:27], v[108:111], v[48:51]
    ds_read_b128 v[100:103], v2 offset:24704
    s_add_u32 m0, s41, 49152
    v_mfma_f32_16x16x32_bf16 v[52:55], a[28:31], v[108:111], v[52:55]
    ds_read_b128 v[104:107], v2 offset:28800
    buffer_load_dwordx4 v11, s[12:15], s76 offen offset:0 lds
    v_mfma_f32_16x16x32_bf16 v[56:59], a[32:35], v[108:111], v[56:59]
    ds_read_b64_tr_b16 a[168:169], v7 offset:24576
    buffer_load_dwordx4 v12, s[12:15], s76 offen offset:1024 lds
    v_mfma_f32_16x16x32_bf16 v[36:39], a[132:135], v[108:111], v[36:39]
    ds_read_b64_tr_b16 a[170:171], v7 offset:25344
    v_mfma_f32_16x16x32_bf16 v[40:43], a[136:139], v[108:111], v[40:43]
    ds_read_b64_tr_b16 a[172:173], v8 offset:24576
    buffer_load_dwordx4 v13, s[12:15], s76 offen offset:2048 lds
    v_mfma_f32_16x16x32_bf16 v[44:47], a[140:143], v[108:111], v[44:47]
    ds_read_b64_tr_b16 a[174:175], v8 offset:25344
    v_mfma_f32_16x16x32_bf16 v[24:27], a[132:135], v[112:115], v[24:27]
    ds_read_b64_tr_b16 a[176:177], v9 offset:24576
    v_mfma_f32_16x16x32_bf16 v[28:31], a[136:139], v[112:115], v[28:31]
    ds_read_b64_tr_b16 a[178:179], v9 offset:25344
    v_mfma_f32_16x16x32_bf16 v[32:35], a[140:143], v[112:115], v[32:35]
    s_waitcnt lgkmcnt(15)
    v_mfma_f32_16x16x32_bf16 v[48:51], a[36:39], v[84:87], v[48:51]
    ds_read_b128 v[108:111], v3 offset:24576
    v_mfma_f32_16x16x32_bf16 v[52:55], a[40:43], v[84:87], v[52:55]
    ds_read_b128 v[112:115], v3 offset:28672
    v_mfma_f32_16x16x32_bf16 v[56:59], a[44:47], v[84:87], v[56:59]
    ds_read_b64_tr_b16 a[180:181], v7 offset:30720
    v_mfma_f32_16x16x32_bf16 v[36:39], a[144:147], v[84:87], v[36:39]
    ds_read_b64_tr_b16 a[182:183], v7 offset:31488
    v_mfma_f32_16x16x32_bf16 v[40:43], a[148:151], v[84:87], v[40:43]
    ds_read_b64_tr_b16 a[184:185], v8 offset:30720
    v_mfma_f32_16x16x32_bf16 v[44:47], a[152:155], v[84:87], v[44:47]
    ds_read_b64_tr_b16 a[186:187], v8 offset:31488
    v_mfma_f32_16x16x32_bf16 v[24:27], a[144:147], v[88:91], v[24:27]
    ds_read_b64_tr_b16 a[188:189], v9 offset:30720
    v_mfma_f32_16x16x32_bf16 v[28:31], a[148:151], v[88:91], v[28:31]
    ds_read_b64_tr_b16 a[190:191], v9 offset:31488
    v_mfma_f32_16x16x32_bf16 v[32:35], a[152:155], v[88:91], v[32:35]
    s_waitcnt vmcnt(12) lgkmcnt(15)
    s_barrier
    v_mfma_f32_16x16x32_bf16 v[48:51], a[48:51], v[92:95], v[48:51]
    ds_read_b128 v[84:87], v3 offset:24640
    s_add_u32 m0, s41, 61440
    v_mfma_f32_16x16x32_bf16 v[52:55], a[52:55], v[92:95], v[52:55]
    ds_read_b128 v[88:91], v3 offset:28736
    buffer_load_dwordx4 v11, s[12:15], s77 offen offset:0 lds
    v_mfma_f32_16x16x32_bf16 v[56:59], a[56:59], v[92:95], v[56:59]
    ds_read_b64_tr_b16 a[192:193], v4 offset:0
    buffer_load_dwordx4 v12, s[12:15], s77 offen offset:1024 lds
    v_mfma_f32_16x16x32_bf16 v[36:39], a[156:159], v[92:95], v[36:39]
    ds_read_b64_tr_b16 a[194:195], v4 offset:768
    v_mfma_f32_16x16x32_bf16 v[40:43], a[160:163], v[92:95], v[40:43]
    ds_read_b64_tr_b16 a[196:197], v5 offset:0
    buffer_load_dwordx4 v13, s[12:15], s77 offen offset:2048 lds
    v_mfma_f32_16x16x32_bf16 v[44:47], a[164:167], v[92:95], v[44:47]
    ds_read_b64_tr_b16 a[198:199], v5 offset:768
    v_mfma_f32_16x16x32_bf16 v[24:27], a[156:159], v[96:99], v[24:27]
    ds_read_b64_tr_b16 a[200:201], v6 offset:0
    v_mfma_f32_16x16x32_bf16 v[28:31], a[160:163], v[96:99], v[28:31]
    ds_read_b64_tr_b16 a[202:203], v6 offset:768
    v_mfma_f32_16x16x32_bf16 v[32:35], a[164:167], v[96:99], v[32:35]
    s_waitcnt lgkmcnt(15)
    v_mfma_f32_16x16x32_bf16 v[48:51], a[60:63], v[100:103], v[48:51]
    ds_read_b128 v[92:95], v3 offset:24704
    s_add_u32 m0, s40, 45056
    v_mfma_f32_16x16x32_bf16 v[52:55], a[64:67], v[100:103], v[52:55]
    ds_read_b128 v[96:99], v3 offset:28800
    buffer_load_dwordx4 v10, s[8:11], s35 offen lds
    v_mfma_f32_16x16x32_bf16 v[56:59], a[68:71], v[100:103], v[56:59]
    ds_read_b64_tr_b16 a[204:205], v4 offset:6144
    s_add_u32 m0, s40, 16384
    v_mfma_f32_16x16x32_bf16 v[36:39], a[168:171], v[100:103], v[36:39]
    ds_read_b64_tr_b16 a[206:207], v4 offset:6912
    buffer_load_dwordx4 v10, s[8:11], s28 offen lds
    v_mfma_f32_16x16x32_bf16 v[40:43], a[172:175], v[100:103], v[40:43]
    ds_read_b64_tr_b16 a[208:209], v5 offset:6144
    s_add_u32 m0, s40, 40960
    v_mfma_f32_16x16x32_bf16 v[44:47], a[176:179], v[100:103], v[44:47]
    ds_read_b64_tr_b16 a[210:211], v5 offset:6912
    buffer_load_dwordx4 v10, s[8:11], s34 offen lds
    v_mfma_f32_16x16x32_bf16 v[24:27], a[168:171], v[104:107], v[24:27]
    ds_read_b64_tr_b16 a[212:213], v6 offset:6144
    v_mfma_f32_16x16x32_bf16 v[28:31], a[172:175], v[104:107], v[28:31]
    ds_read_b64_tr_b16 a[214:215], v6 offset:6912
    v_mfma_f32_16x16x32_bf16 v[32:35], a[176:179], v[104:107], v[32:35]
    s_waitcnt vmcnt(15) lgkmcnt(15)
    s_barrier
    v_mfma_f32_16x16x32_bf16 v[48:51], a[72:75], v[108:111], v[48:51]
    ds_read_b128 v[100:103], v1 offset:20480
    s_add_u32 m0, s40, 12288
    v_mfma_f32_16x16x32_bf16 v[52:55], a[76:79], v[108:111], v[52:55]
    ds_read_b128 v[104:107], v1 offset:24576
    buffer_load_dwordx4 v10, s[8:11], s27 offen lds
    v_mfma_f32_16x16x32_bf16 v[56:59], a[80:83], v[108:111], v[56:59]
    ds_read_b64_tr_b16 a[216:217], v4 offset:12288
    s_add_u32 m0, s40, 36864
    v_mfma_f32_16x16x32_bf16 v[36:39], a[180:183], v[108:111], v[36:39]
    ds_read_b64_tr_b16 a[218:219], v4 offset:13056
    buffer_load_dwordx4 v10, s[8:11], s33 offen lds
    v_mfma_f32_16x16x32_bf16 v[40:43], a[184:187], v[108:111], v[40:43]
    ds_read_b64_tr_b16 a[220:221], v5 offset:12288
    s_add_u32 m0, s40, 8192
    v_mfma_f32_16x16x32_bf16 v[44:47], a[188:191], v[108:111], v[44:47]
    ds_read_b64_tr_b16 a[222:223], v5 offset:13056
    buffer_load_dwordx4 v10, s[8:11], s26 offen lds
    v_mfma_f32_16x16x32_bf16 v[24:27], a[180:183], v[112:115], v[24:27]
    ds_read_b64_tr_b16 a[224:225], v6 offset:12288
    v_mfma_f32_16x16x32_bf16 v[28:31], a[184:187], v[112:115], v[28:31]
    ds_read_b64_tr_b16 a[226:227], v6 offset:13056
    v_mfma_f32_16x16x32_bf16 v[32:35], a[188:191], v[112:115], v[32:35]
    s_waitcnt lgkmcnt(15)
    v_mfma_f32_16x16x32_bf16 v[48:51], a[84:87], v[84:87], v[48:51]
    ds_read_b128 v[108:111], v1 offset:20544
    s_add_u32 m0, s40, 4096
    v_mfma_f32_16x16x32_bf16 v[52:55], a[88:91], v[84:87], v[52:55]
    ds_read_b128 v[112:115], v1 offset:24640
    buffer_load_dwordx4 v10, s[8:11], s25 offen lds
    v_mfma_f32_16x16x32_bf16 v[56:59], a[92:95], v[84:87], v[56:59]
    ds_read_b64_tr_b16 a[228:229], v4 offset:18432
    s_add_u32 m0, s40, 0
    v_mfma_f32_16x16x32_bf16 v[36:39], a[192:195], v[84:87], v[36:39]
    ds_read_b64_tr_b16 a[230:231], v4 offset:19200
    buffer_load_dwordx4 v10, s[8:11], s24 offen lds
    v_mfma_f32_16x16x32_bf16 v[40:43], a[196:199], v[84:87], v[40:43]
    ds_read_b64_tr_b16 a[232:233], v5 offset:18432
    v_mfma_f32_16x16x32_bf16 v[44:47], a[200:203], v[84:87], v[44:47]
    ds_read_b64_tr_b16 a[234:235], v5 offset:19200
    v_mfma_f32_16x16x32_bf16 v[24:27], a[192:195], v[88:91], v[24:27]
    ds_read_b64_tr_b16 a[236:237], v6 offset:18432
    v_mfma_f32_16x16x32_bf16 v[28:31], a[196:199], v[88:91], v[28:31]
    ds_read_b64_tr_b16 a[238:239], v6 offset:19200
    v_mfma_f32_16x16x32_bf16 v[32:35], a[200:203], v[88:91], v[32:35]
    s_waitcnt vmcnt(17) lgkmcnt(15)
    s_barrier
    v_mfma_f32_16x16x32_bf16 v[48:51], a[96:99], v[92:95], v[48:51]
    ds_read_b128 v[84:87], v1 offset:20608
    v_mfma_f32_16x16x32_bf16 v[52:55], a[100:103], v[92:95], v[52:55]
    ds_read_b128 v[88:91], v1 offset:24704
    v_mfma_f32_16x16x32_bf16 v[56:59], a[104:107], v[92:95], v[56:59]
    ds_read_b64_tr_b16 a[240:241], v4 offset:24576
    v_mfma_f32_16x16x32_bf16 v[36:39], a[204:207], v[92:95], v[36:39]
    ds_read_b64_tr_b16 a[242:243], v4 offset:25344
    v_mfma_f32_16x16x32_bf16 v[40:43], a[208:211], v[92:95], v[40:43]
    ds_read_b64_tr_b16 a[244:245], v5 offset:24576
    v_mfma_f32_16x16x32_bf16 v[44:47], a[212:215], v[92:95], v[44:47]
    ds_read_b64_tr_b16 a[246:247], v5 offset:25344
    v_mfma_f32_16x16x32_bf16 v[24:27], a[204:207], v[96:99], v[24:27]
    ds_read_b64_tr_b16 a[248:249], v6 offset:24576
    v_mfma_f32_16x16x32_bf16 v[28:31], a[208:211], v[96:99], v[28:31]
    ds_read_b64_tr_b16 a[250:251], v6 offset:25344
    v_mfma_f32_16x16x32_bf16 v[32:35], a[212:215], v[96:99], v[32:35]
    s_waitcnt lgkmcnt(15)
    v_mfma_f32_16x16x32_bf16 v[60:63], a[0:3], v[100:103], 0
    ds_read_b128 v[92:95], v2 offset:20480
    v_mfma_f32_16x16x32_bf16 v[64:67], a[4:7], v[100:103], 0
    ds_read_b128 v[96:99], v2 offset:24576
    v_mfma_f32_16x16x32_bf16 v[68:71], a[8:11], v[100:103], 0
    ds_read_b64_tr_b16 v[132:133], v4 offset:30720
    v_mfma_f32_16x16x32_bf16 v[48:51], a[108:111], v[100:103], v[48:51]
    ds_read_b64_tr_b16 v[134:135], v4 offset:31488
    v_mfma_f32_16x16x32_bf16 v[52:55], a[112:115], v[100:103], v[52:55]
    ds_read_b64_tr_b16 v[136:137], v5 offset:30720
    v_mfma_f32_16x16x32_bf16 v[56:59], a[116:119], v[100:103], v[56:59]
    ds_read_b64_tr_b16 v[138:139], v5 offset:31488
    v_mfma_f32_16x16x32_bf16 v[36:39], a[216:219], v[100:103], v[36:39]
    ds_read_b64_tr_b16 v[140:141], v6 offset:30720
    v_mfma_f32_16x16x32_bf16 v[40:43], a[220:223], v[100:103], v[40:43]
    ds_read_b64_tr_b16 v[142:143], v6 offset:31488
    v_mfma_f32_16x16x32_bf16 v[44:47], a[224:227], v[100:103], v[44:47]
    v_mfma_f32_16x16x32_bf16 v[24:27], a[216:219], v[104:107], v[24:27]
    v_mfma_f32_16x16x32_bf16 v[28:31], a[220:223], v[104:107], v[28:31]
    v_mfma_f32_16x16x32_bf16 v[32:35], a[224:227], v[104:107], v[32:35]
    s_waitcnt vmcnt(14) lgkmcnt(15)
    s_barrier
    v_mfma_f32_16x16x32_bf16 v[60:63], a[12:15], v[108:111], v[60:63]
    ds_read_b128 v[100:103], v2 offset:20544
    v_mfma_f32_16x16x32_bf16 v[64:67], a[16:19], v[108:111], v[64:67]
    ds_read_b128 v[104:107], v2 offset:24640
    v_mfma_f32_16x16x32_bf16 v[68:71], a[20:23], v[108:111], v[68:71]
    ds_read_b64_tr_b16 v[144:145], v4 offset:36864
    v_mfma_f32_16x16x32_bf16 v[48:51], a[120:123], v[108:111], v[48:51]
    ds_read_b64_tr_b16 v[146:147], v4 offset:37632
    v_mfma_f32_16x16x32_bf16 v[52:55], a[124:127], v[108:111], v[52:55]
    ds_read_b64_tr_b16 v[148:149], v5 offset:36864
    v_mfma_f32_16x16x32_bf16 v[56:59], a[128:131], v[108:111], v[56:59]
    ds_read_b64_tr_b16 v[150:151], v5 offset:37632
    v_mfma_f32_16x16x32_bf16 v[36:39], a[228:231], v[108:111], v[36:39]
    ds_read_b64_tr_b16 v[152:153], v6 offset:36864
    v_mfma_f32_16x16x32_bf16 v[40:43], a[232:235], v[108:111], v[40:43]
    ds_read_b64_tr_b16 v[154:155], v6 offset:37632
    v_mfma_f32_16x16x32_bf16 v[44:47], a[236:239], v[108:111], v[44:47]
    v_mfma_f32_16x16x32_bf16 v[24:27], a[228:231], v[112:115], v[24:27]
    v_mfma_f32_16x16x32_bf16 v[28:31], a[232:235], v[112:115], v[28:31]
    v_mfma_f32_16x16x32_bf16 v[32:35], a[236:239], v[112:115], v[32:35]
    s_waitcnt lgkmcnt(15)
    v_mfma_f32_16x16x32_bf16 v[60:63], a[24:27], v[84:87], v[60:63]
    ds_read_b128 v[108:111], v2 offset:20608
    v_mfma_f32_16x16x32_bf16 v[64:67], a[28:31], v[84:87], v[64:67]
    ds_read_b128 v[112:115], v2 offset:24704
    v_mfma_f32_16x16x32_bf16 v[68:71], a[32:35], v[84:87], v[68:71]
    ds_read_b64_tr_b16 v[156:157], v4 offset:43008
    v_mfma_f32_16x16x32_bf16 v[48:51], a[132:135], v[84:87], v[48:51]
    ds_read_b64_tr_b16 v[158:159], v4 offset:43776
    v_mfma_f32_16x16x32_bf16 v[52:55], a[136:139], v[84:87], v[52:55]
    ds_read_b64_tr_b16 v[160:161], v5 offset:43008
    v_mfma_f32_16x16x32_bf16 v[56:59], a[140:143], v[84:87], v[56:59]
    ds_read_b64_tr_b16 v[162:163], v5 offset:43776
    v_mfma_f32_16x16x32_bf16 v[36:39], a[240:243], v[84:87], v[36:39]
    ds_read_b64_tr_b16 v[164:165], v6 offset:43008
    v_mfma_f32_16x16x32_bf16 v[40:43], a[244:247], v[84:87], v[40:43]
    ds_read_b64_tr_b16 v[166:167], v6 offset:43776
    v_mfma_f32_16x16x32_bf16 v[44:47], a[248:251], v[84:87], v[44:47]
    v_mfma_f32_16x16x32_bf16 v[24:27], a[240:243], v[88:91], v[24:27]
    v_mfma_f32_16x16x32_bf16 v[28:31], a[244:247], v[88:91], v[28:31]
    v_mfma_f32_16x16x32_bf16 v[32:35], a[248:251], v[88:91], v[32:35]
    s_waitcnt vmcnt(11) lgkmcnt(15)
    s_barrier
    v_mfma_f32_16x16x32_bf16 v[60:63], a[36:39], v[92:95], v[60:63]
    ds_read_b128 v[84:87], v3 offset:20480
    v_mfma_f32_16x16x32_bf16 v[64:67], a[40:43], v[92:95], v[64:67]
    ds_read_b128 v[88:91], v3 offset:24576
    v_mfma_f32_16x16x32_bf16 v[68:71], a[44:47], v[92:95], v[68:71]
    ds_read_b64_tr_b16 v[168:169], v4 offset:49152
    v_mfma_f32_16x16x32_bf16 v[48:51], a[144:147], v[92:95], v[48:51]
    ds_read_b64_tr_b16 v[170:171], v4 offset:49920
    v_mfma_f32_16x16x32_bf16 v[52:55], a[148:151], v[92:95], v[52:55]
    ds_read_b64_tr_b16 v[172:173], v5 offset:49152
    v_mfma_f32_16x16x32_bf16 v[56:59], a[152:155], v[92:95], v[56:59]
    ds_read_b64_tr_b16 v[174:175], v5 offset:49920
    v_mfma_f32_16x16x32_bf16 v[36:39], v[132:135], v[92:95], v[36:39]
    ds_read_b64_tr_b16 v[176:177], v6 offset:49152
    v_mfma_f32_16x16x32_bf16 v[40:43], v[136:139], v[92:95], v[40:43]
    ds_read_b64_tr_b16 v[178:179], v6 offset:49920
    v_mfma_f32_16x16x32_bf16 v[44:47], v[140:143], v[92:95], v[44:47]
    v_mfma_f32_16x16x32_bf16 v[24:27], v[132:135], v[96:99], v[24:27]
    v_mfma_f32_16x16x32_bf16 v[28:31], v[136:139], v[96:99], v[28:31]
    v_mfma_f32_16x16x32_bf16 v[32:35], v[140:143], v[96:99], v[32:35]
    s_waitcnt lgkmcnt(15)
    v_mfma_f32_16x16x32_bf16 v[60:63], a[48:51], v[100:103], v[60:63]
    ds_read_b128 v[92:95], v3 offset:20544
    v_mfma_f32_16x16x32_bf16 v[64:67], a[52:55], v[100:103], v[64:67]
    ds_read_b128 v[96:99], v3 offset:24640
    v_mfma_f32_16x16x32_bf16 v[68:71], a[56:59], v[100:103], v[68:71]
    ds_read_b64_tr_b16 v[180:181], v4 offset:55296
    v_mfma_f32_16x16x32_bf16 v[48:51], a[156:159], v[100:103], v[48:51]
    ds_read_b64_tr_b16 v[182:183], v4 offset:56064
    v_mfma_f32_16x16x32_bf16 v[52:55], a[160:163], v[100:103], v[52:55]
    ds_read_b64_tr_b16 v[184:185], v5 offset:55296
    v_mfma_f32_16x16x32_bf16 v[56:59], a[164:167], v[100:103], v[56:59]
    ds_read_b64_tr_b16 v[186:187], v5 offset:56064
    v_mfma_f32_16x16x32_bf16 v[36:39], v[144:147], v[100:103], v[36:39]
    ds_read_b64_tr_b16 v[188:189], v6 offset:55296
    v_mfma_f32_16x16x32_bf16 v[40:43], v[148:151], v[100:103], v[40:43]
    ds_read_b64_tr_b16 v[190:191], v6 offset:56064
    v_mfma_f32_16x16x32_bf16 v[44:47], v[152:155], v[100:103], v[44:47]
    v_mfma_f32_16x16x32_bf16 v[24:27], v[144:147], v[104:107], v[24:27]
    v_mfma_f32_16x16x32_bf16 v[28:31], v[148:151], v[104:107], v[28:31]
    v_mfma_f32_16x16x32_bf16 v[32:35], v[152:155], v[104:107], v[32:35]
    s_waitcnt vmcnt(6) lgkmcnt(15)
    s_barrier
    v_mfma_f32_16x16x32_bf16 v[60:63], a[60:63], v[108:111], v[60:63]
    ds_read_b128 v[100:103], v3 offset:20608
    v_mfma_f32_16x16x32_bf16 v[64:67], a[64:67], v[108:111], v[64:67]
    ds_read_b128 v[104:107], v3 offset:24704
    v_mfma_f32_16x16x32_bf16 v[68:71], a[68:71], v[108:111], v[68:71]
    ds_read_b64_tr_b16 v[192:193], v7 offset:0
    v_mfma_f32_16x16x32_bf16 v[48:51], a[168:171], v[108:111], v[48:51]
    ds_read_b64_tr_b16 v[194:195], v7 offset:768
    v_mfma_f32_16x16x32_bf16 v[52:55], a[172:175], v[108:111], v[52:55]
    ds_read_b64_tr_b16 v[196:197], v8 offset:0
    v_mfma_f32_16x16x32_bf16 v[56:59], a[176:179], v[108:111], v[56:59]
    ds_read_b64_tr_b16 v[198:199], v8 offset:768
    v_mfma_f32_16x16x32_bf16 v[36:39], v[156:159], v[108:111], v[36:39]
    ds_read_b64_tr_b16 v[200:201], v9 offset:0
    v_mfma_f32_16x16x32_bf16 v[40:43], v[160:163], v[108:111], v[40:43]
    ds_read_b64_tr_b16 v[202:203], v9 offset:768
    v_mfma_f32_16x16x32_bf16 v[44:47], v[164:167], v[108:111], v[44:47]
    v_mfma_f32_16x16x32_bf16 v[24:27], v[156:159], v[112:115], v[24:27]
    v_mfma_f32_16x16x32_bf16 v[28:31], v[160:163], v[112:115], v[28:31]
    v_mfma_f32_16x16x32_bf16 v[32:35], v[164:167], v[112:115], v[32:35]
    s_waitcnt lgkmcnt(15)
    v_mfma_f32_16x16x32_bf16 v[60:63], a[72:75], v[84:87], v[60:63]
    ds_read_b128 v[108:111], v1 offset:16384
    v_mfma_f32_16x16x32_bf16 v[64:67], a[76:79], v[84:87], v[64:67]
    v_mfma_f32_16x16x32_bf16 v[68:71], a[80:83], v[84:87], v[68:71]
    v_mfma_f32_16x16x32_bf16 v[48:51], a[180:183], v[84:87], v[48:51]
    v_mfma_f32_16x16x32_bf16 v[52:55], a[184:187], v[84:87], v[52:55]
    v_mfma_f32_16x16x32_bf16 v[56:59], a[188:191], v[84:87], v[56:59]
    v_mfma_f32_16x16x32_bf16 v[36:39], v[168:171], v[84:87], v[36:39]
    v_mfma_f32_16x16x32_bf16 v[40:43], v[172:175], v[84:87], v[40:43]
    v_mfma_f32_16x16x32_bf16 v[44:47], v[176:179], v[84:87], v[44:47]
    v_mfma_f32_16x16x32_bf16 v[24:27], v[168:171], v[88:91], v[24:27]
    v_mfma_f32_16x16x32_bf16 v[28:31], v[172:175], v[88:91], v[28:31]
    v_mfma_f32_16x16x32_bf16 v[32:35], v[176:179], v[88:91], v[32:35]
    s_waitcnt lgkmcnt(9)
    v_mfma_f32_16x16x32_bf16 v[60:63], a[84:87], v[92:95], v[60:63]
    ds_read_b128 v[112:115], v1 offset:16448
    v_mfma_f32_16x16x32_bf16 v[64:67], a[88:91], v[92:95], v[64:67]
    v_mfma_f32_16x16x32_bf16 v[68:71], a[92:95], v[92:95], v[68:71]
    v_mfma_f32_16x16x32_bf16 v[48:51], a[192:195], v[92:95], v[48:51]
    v_mfma_f32_16x16x32_bf16 v[52:55], a[196:199], v[92:95], v[52:55]
    v_mfma_f32_16x16x32_bf16 v[56:59], a[200:203], v[92:95], v[56:59]
    v_mfma_f32_16x16x32_bf16 v[36:39], v[180:183], v[92:95], v[36:39]
    v_mfma_f32_16x16x32_bf16 v[40:43], v[184:187], v[92:95], v[40:43]
    v_mfma_f32_16x16x32_bf16 v[44:47], v[188:191], v[92:95], v[44:47]
    v_mfma_f32_16x16x32_bf16 v[24:27], v[180:183], v[96:99], v[24:27]
    v_mfma_f32_16x16x32_bf16 v[28:31], v[184:187], v[96:99], v[28:31]
    v_mfma_f32_16x16x32_bf16 v[32:35], v[188:191], v[96:99], v[32:35]
    s_waitcnt lgkmcnt(2)
    v_mfma_f32_16x16x32_bf16 v[60:63], a[96:99], v[100:103], v[60:63]
    ds_read_b128 v[84:87], v1 offset:16512
    v_mfma_f32_16x16x32_bf16 v[64:67], a[100:103], v[100:103], v[64:67]
    v_mfma_f32_16x16x32_bf16 v[68:71], a[104:107], v[100:103], v[68:71]
    v_mfma_f32_16x16x32_bf16 v[48:51], a[204:207], v[100:103], v[48:51]
    v_mfma_f32_16x16x32_bf16 v[52:55], a[208:211], v[100:103], v[52:55]
    v_mfma_f32_16x16x32_bf16 v[56:59], a[212:215], v[100:103], v[56:59]
    v_mfma_f32_16x16x32_bf16 v[36:39], v[192:195], v[100:103], v[36:39]
    v_mfma_f32_16x16x32_bf16 v[40:43], v[196:199], v[100:103], v[40:43]
    v_mfma_f32_16x16x32_bf16 v[44:47], v[200:203], v[100:103], v[44:47]
    v_mfma_f32_16x16x32_bf16 v[24:27], v[192:195], v[104:107], v[24:27]
    v_mfma_f32_16x16x32_bf16 v[28:31], v[196:199], v[104:107], v[28:31]
    v_mfma_f32_16x16x32_bf16 v[32:35], v[200:203], v[104:107], v[32:35]
    s_waitcnt lgkmcnt(2)
    v_mfma_f32_16x16x32_bf16 v[72:75], a[0:3], v[108:111], 0
    ds_read_b128 v[88:91], v2 offset:16384
    v_mfma_f32_16x16x32_bf16 v[76:79], a[4:7], v[108:111], 0
    v_mfma_f32_16x16x32_bf16 v[80:83], a[8:11], v[108:111], 0
    v_mfma_f32_16x16x32_bf16 v[60:63], a[108:111], v[108:111], v[60:63]
    v_mfma_f32_16x16x32_bf16 v[64:67], a[112:115], v[108:111], v[64:67]
    v_mfma_f32_16x16x32_bf16 v[68:71], a[116:119], v[108:111], v[68:71]
    v_mfma_f32_16x16x32_bf16 v[48:51], a[216:219], v[108:111], v[48:51]
    v_mfma_f32_16x16x32_bf16 v[52:55], a[220:223], v[108:111], v[52:55]
    v_mfma_f32_16x16x32_bf16 v[56:59], a[224:227], v[108:111], v[56:59]
    v_cvt_pk_bf16_f32 v116, v24, v25
    s_waitcnt lgkmcnt(2)
    v_mfma_f32_16x16x32_bf16 v[72:75], a[12:15], v[112:115], v[72:75]
    ds_read_b128 v[92:95], v2 offset:16448
    v_cvt_pk_bf16_f32 v117, v26, v27
    v_mfma_f32_16x16x32_bf16 v[76:79], a[16:19], v[112:115], v[76:79]
    v_cvt_pk_bf16_f32 v118, v28, v29
    v_mfma_f32_16x16x32_bf16 v[80:83], a[20:23], v[112:115], v[80:83]
    v_cvt_pk_bf16_f32 v119, v30, v31
    v_mfma_f32_16x16x32_bf16 v[60:63], a[120:123], v[112:115], v[60:63]
    v_cvt_pk_bf16_f32 v120, v32, v33
    v_mfma_f32_16x16x32_bf16 v[64:67], a[124:127], v[112:115], v[64:67]
    v_cvt_pk_bf16_f32 v121, v34, v35
    v_mfma_f32_16x16x32_bf16 v[68:71], a[128:131], v[112:115], v[68:71]
    s_add_u32 s43, s42, 258048
    v_mfma_f32_16x16x32_bf16 v[48:51], a[228:231], v[112:115], v[48:51]
    ds_write_b64 v20, v[120:121] offset:0
    v_mfma_f32_16x16x32_bf16 v[52:55], a[232:235], v[112:115], v[52:55]
    v_permlane16_swap_b32 v116, v118
    v_mfma_f32_16x16x32_bf16 v[56:59], a[236:239], v[112:115], v[56:59]
    v_permlane16_swap_b32 v117, v119
    s_waitcnt lgkmcnt(3)
    v_mfma_f32_16x16x32_bf16 v[72:75], a[24:27], v[84:87], v[72:75]
    ds_read_b128 v[96:99], v2 offset:16512
    buffer_store_dwordx4 v[116:119], v14, s[16:19], s43 offen sc1
    v_mfma_f32_16x16x32_bf16 v[76:79], a[28:31], v[84:87], v[76:79]
    v_cvt_pk_bf16_f32 v124, v36, v37
    v_mfma_f32_16x16x32_bf16 v[80:83], a[32:35], v[84:87], v[80:83]
    v_cvt_pk_bf16_f32 v125, v38, v39
    v_mfma_f32_16x16x32_bf16 v[60:63], a[132:135], v[84:87], v[60:63]
    v_cvt_pk_bf16_f32 v126, v40, v41
    v_mfma_f32_16x16x32_bf16 v[64:67], a[136:139], v[84:87], v[64:67]
    v_cvt_pk_bf16_f32 v127, v42, v43
    v_mfma_f32_16x16x32_bf16 v[68:71], a[140:143], v[84:87], v[68:71]
    v_cvt_pk_bf16_f32 v128, v44, v45
    v_mfma_f32_16x16x32_bf16 v[48:51], a[240:243], v[84:87], v[48:51]
    v_cvt_pk_bf16_f32 v129, v46, v47
    v_mfma_f32_16x16x32_bf16 v[52:55], a[244:247], v[84:87], v[52:55]
    s_add_u32 s43, s42, 215040
    v_mfma_f32_16x16x32_bf16 v[56:59], a[248:251], v[84:87], v[56:59]
    ds_write_b64 v20, v[128:129] offset:2080
    s_waitcnt lgkmcnt(4)
    v_mfma_f32_16x16x32_bf16 v[72:75], a[36:39], v[88:91], v[72:75]
    ds_read_b128 v[100:103], v3 offset:16384
    v_permlane16_swap_b32 v124, v126
    v_mfma_f32_16x16x32_bf16 v[76:79], a[40:43], v[88:91], v[76:79]
    v_permlane16_swap_b32 v125, v127
    v_mfma_f32_16x16x32_bf16 v[80:83], a[44:47], v[88:91], v[80:83]
    buffer_store_dwordx4 v[124:127], v14, s[16:19], s43 offen sc1
    v_mfma_f32_16x16x32_bf16 v[60:63], a[144:147], v[88:91], v[60:63]
    v_mfma_f32_16x16x32_bf16 v[64:67], a[148:151], v[88:91], v[64:67]
    v_mfma_f32_16x16x32_bf16 v[68:71], a[152:155], v[88:91], v[68:71]
    v_mfma_f32_16x16x32_bf16 v[48:51], v[132:135], v[88:91], v[48:51]
    v_mfma_f32_16x16x32_bf16 v[52:55], v[136:139], v[88:91], v[52:55]
    v_mfma_f32_16x16x32_bf16 v[56:59], v[140:143], v[88:91], v[56:59]
    s_waitcnt lgkmcnt(4)
    v_mfma_f32_16x16x32_bf16 v[72:75], a[48:51], v[92:95], v[72:75]
    ds_read_b128 v[104:107], v3 offset:16448
    v_mfma_f32_16x16x32_bf16 v[76:79], a[52:55], v[92:95], v[76:79]
    v_mfma_f32_16x16x32_bf16 v[80:83], a[56:59], v[92:95], v[80:83]
    v_mfma_f32_16x16x32_bf16 v[60:63], a[156:159], v[92:95], v[60:63]
    v_mfma_f32_16x16x32_bf16 v[64:67], a[160:163], v[92:95], v[64:67]
    v_mfma_f32_16x16x32_bf16 v[68:71], a[164:167], v[92:95], v[68:71]
    v_mfma_f32_16x16x32_bf16 v[48:51], v[144:147], v[92:95], v[48:51]
    v_mfma_f32_16x16x32_bf16 v[52:55], v[148:151], v[92:95], v[52:55]
    v_mfma_f32_16x16x32_bf16 v[56:59], v[152:155], v[92:95], v[56:59]
    s_waitcnt lgkmcnt(3)
    s_barrier
    v_mfma_f32_16x16x32_bf16 v[72:75], a[60:63], v[96:99], v[72:75]
    ds_read_b128 v[108:111], v3 offset:16512
    ds_read_b64 v[122:123], v19 offset:0
    v_mfma_f32_16x16x32_bf16 v[76:79], a[64:67], v[96:99], v[76:79]
    v_mfma_f32_16x16x32_bf16 v[80:83], a[68:71], v[96:99], v[80:83]
    v_mfma_f32_16x16x32_bf16 v[60:63], a[168:171], v[96:99], v[60:63]
    v_mfma_f32_16x16x32_bf16 v[64:67], a[172:175], v[96:99], v[64:67]
    v_mfma_f32_16x16x32_bf16 v[68:71], a[176:179], v[96:99], v[68:71]
    v_mfma_f32_16x16x32_bf16 v[48:51], v[156:159], v[96:99], v[48:51]
    v_mfma_f32_16x16x32_bf16 v[52:55], v[160:163], v[96:99], v[52:55]
    v_mfma_f32_16x16x32_bf16 v[56:59], v[164:167], v[96:99], v[56:59]
    s_waitcnt vmcnt(2) lgkmcnt(3)
    s_barrier
    v_mfma_f32_16x16x32_bf16 v[72:75], a[72:75], v[100:103], v[72:75]
    ds_read_b128 v[112:115], v1 offset:12288
    ds_read_b64 v[130:131], v19 offset:2080
    v_mfma_f32_16x16x32_bf16 v[76:79], a[76:79], v[100:103], v[76:79]
    v_mfma_f32_16x16x32_bf16 v[80:83], a[80:83], v[100:103], v[80:83]
    v_mfma_f32_16x16x32_bf16 v[60:63], a[180:183], v[100:103], v[60:63]
    v_mfma_f32_16x16x32_bf16 v[64:67], a[184:187], v[100:103], v[64:67]
    v_mfma_f32_16x16x32_bf16 v[68:71], a[188:191], v[100:103], v[68:71]
    v_mfma_f32_16x16x32_bf16 v[48:51], v[168:171], v[100:103], v[48:51]
    v_mfma_f32_16x16x32_bf16 v[52:55], v[172:175], v[100:103], v[52:55]
    v_mfma_f32_16x16x32_bf16 v[56:59], v[176:179], v[100:103], v[56:59]
    s_waitcnt lgkmcnt(4)
    v_mfma_f32_16x16x32_bf16 v[72:75], a[84:87], v[104:107], v[72:75]
    ds_read_b128 v[84:87], v1 offset:12352
    v_mfma_f32_16x16x32_bf16 v[76:79], a[88:91], v[104:107], v[76:79]
    v_mfma_f32_16x16x32_bf16 v[80:83], a[92:95], v[104:107], v[80:83]
    v_mfma_f32_16x16x32_bf16 v[60:63], a[192:195], v[104:107], v[60:63]
    v_mfma_f32_16x16x32_bf16 v[64:67], a[196:199], v[104:107], v[64:67]
    v_mfma_f32_16x16x32_bf16 v[68:71], a[200:203], v[104:107], v[68:71]
    v_mfma_f32_16x16x32_bf16 v[48:51], v[180:183], v[104:107], v[48:51]
    v_mfma_f32_16x16x32_bf16 v[52:55], v[184:187], v[104:107], v[52:55]
    v_mfma_f32_16x16x32_bf16 v[56:59], v[188:191], v[104:107], v[56:59]
    s_waitcnt lgkmcnt(4)
    v_mfma_f32_16x16x32_bf16 v[72:75], a[96:99], v[108:111], v[72:75]
    ds_read_b128 v[88:91], v1 offset:12416
    v_mfma_f32_16x16x32_bf16 v[76:79], a[100:103], v[108:111], v[76:79]
    v_mfma_f32_16x16x32_bf16 v[80:83], a[104:107], v[108:111], v[80:83]
    v_mfma_f32_16x16x32_bf16 v[60:63], a[204:207], v[108:111], v[60:63]
    v_mfma_f32_16x16x32_bf16 v[64:67], a[208:211], v[108:111], v[64:67]
    v_mfma_f32_16x16x32_bf16 v[68:71], a[212:215], v[108:111], v[68:71]
    v_mfma_f32_16x16x32_bf16 v[48:51], v[192:195], v[108:111], v[48:51]
    v_mfma_f32_16x16x32_bf16 v[52:55], v[196:199], v[108:111], v[52:55]
    v_mfma_f32_16x16x32_bf16 v[56:59], v[200:203], v[108:111], v[56:59]
    s_waitcnt lgkmcnt(3)
    v_mfma_f32_16x16x32_bf16 v[24:27], a[0:3], v[112:115], 0
    ds_read_b128 v[92:95], v2 offset:12288
    v_mfma_f32_16x16x32_bf16 v[28:31], a[4:7], v[112:115], 0
    v_mfma_f32_16x16x32_bf16 v[32:35], a[8:11], v[112:115], 0
    v_mfma_f32_16x16x32_bf16 v[72:75], a[108:111], v[112:115], v[72:75]
    v_mfma_f32_16x16x32_bf16 v[76:79], a[112:115], v[112:115], v[76:79]
    v_mfma_f32_16x16x32_bf16 v[80:83], a[116:119], v[112:115], v[80:83]
    v_mfma_f32_16x16x32_bf16 v[60:63], a[216:219], v[112:115], v[60:63]
    v_mfma_f32_16x16x32_bf16 v[64:67], a[220:223], v[112:115], v[64:67]
    v_mfma_f32_16x16x32_bf16 v[68:71], a[224:227], v[112:115], v[68:71]
    v_cvt_pk_bf16_f32 v116, v48, v49
    s_waitcnt lgkmcnt(2)
    v_mfma_f32_16x16x32_bf16 v[24:27], a[12:15], v[84:87], v[24:27]
    ds_read_b128 v[96:99], v2 offset:12352
    v_cvt_pk_bf16_f32 v117, v50, v51
    v_mfma_f32_16x16x32_bf16 v[28:31], a[16:19], v[84:87], v[28:31]
    v_cvt_pk_bf16_f32 v118, v52, v53
    v_mfma_f32_16x16x32_bf16 v[32:35], a[20:23], v[84:87], v[32:35]
    v_cvt_pk_bf16_f32 v119, v54, v55
    v_mfma_f32_16x16x32_bf16 v[72:75], a[120:123], v[84:87], v[72:75]
    v_cvt_pk_bf16_f32 v120, v56, v57
    v_mfma_f32_16x16x32_bf16 v[76:79], a[124:127], v[84:87], v[76:79]
    v_cvt_pk_bf16_f32 v121, v58, v59
    v_mfma_f32_16x16x32_bf16 v[80:83], a[128:131], v[84:87], v[80:83]
    s_add_u32 s43, s42, 172032
    v_mfma_f32_16x16x32_bf16 v[60:63], a[228:231], v[84:87], v[60:63]
    ds_write_b64 v20, v[120:121] offset:4160
    v_mfma_f32_16x16x32_bf16 v[64:67], a[232:235], v[84:87], v[64:67]
    v_permlane16_swap_b32 v116, v118
    v_mfma_f32_16x16x32_bf16 v[68:71], a[236:239], v[84:87], v[68:71]
    v_permlane16_swap_b32 v117, v119
    s_waitcnt lgkmcnt(3)
    v_mfma_f32_16x16x32_bf16 v[24:27], a[24:27], v[88:91], v[24:27]
    ds_read_b128 v[100:103], v2 offset:12416
    buffer_store_dwordx4 v[116:119], v14, s[16:19], s43 offen sc1
    v_mfma_f32_16x16x32_bf16 v[28:31], a[28:31], v[88:91], v[28:31]
    s_add_u32 s44, s42, 258048
    v_mfma_f32_16x16x32_bf16 v[32:35], a[32:35], v[88:91], v[32:35]
    buffer_store_dwordx2 v[122:123], v18, s[16:19], s44 offen sc1
    v_mfma_f32_16x16x32_bf16 v[72:75], a[132:135], v[88:91], v[72:75]
    s_add_u32 s44, s42, 215040
    v_mfma_f32_16x16x32_bf16 v[76:79], a[136:139], v[88:91], v[76:79]
    buffer_store_dwordx2 v[130:131], v18, s[16:19], s44 offen sc1
    v_mfma_f32_16x16x32_bf16 v[80:83], a[140:143], v[88:91], v[80:83]
    v_mfma_f32_16x16x32_bf16 v[60:63], a[240:243], v[88:91], v[60:63]
    v_mfma_f32_16x16x32_bf16 v[64:67], a[244:247], v[88:91], v[64:67]
    v_mfma_f32_16x16x32_bf16 v[68:71], a[248:251], v[88:91], v[68:71]
    s_waitcnt lgkmcnt(3)
    v_mfma_f32_16x16x32_bf16 v[24:27], a[36:39], v[92:95], v[24:27]
    ds_read_b128 v[104:107], v3 offset:12288
    v_mfma_f32_16x16x32_bf16 v[28:31], a[40:43], v[92:95], v[28:31]
    v_mfma_f32_16x16x32_bf16 v[32:35], a[44:47], v[92:95], v[32:35]
    v_mfma_f32_16x16x32_bf16 v[72:75], a[144:147], v[92:95], v[72:75]
    v_mfma_f32_16x16x32_bf16 v[76:79], a[148:151], v[92:95], v[76:79]
    v_mfma_f32_16x16x32_bf16 v[80:83], a[152:155], v[92:95], v[80:83]
    v_mfma_f32_16x16x32_bf16 v[60:63], v[132:135], v[92:95], v[60:63]
    v_mfma_f32_16x16x32_bf16 v[64:67], v[136:139], v[92:95], v[64:67]
    v_mfma_f32_16x16x32_bf16 v[68:71], v[140:143], v[92:95], v[68:71]
    s_waitcnt lgkmcnt(3)
    v_mfma_f32_16x16x32_bf16 v[24:27], a[48:51], v[96:99], v[24:27]
    ds_read_b128 v[108:111], v3 offset:12352
    v_mfma_f32_16x16x32_bf16 v[28:31], a[52:55], v[96:99], v[28:31]
    v_mfma_f32_16x16x32_bf16 v[32:35], a[56:59], v[96:99], v[32:35]
    v_mfma_f32_16x16x32_bf16 v[72:75], a[156:159], v[96:99], v[72:75]
    v_mfma_f32_16x16x32_bf16 v[76:79], a[160:163], v[96:99], v[76:79]
    v_mfma_f32_16x16x32_bf16 v[80:83], a[164:167], v[96:99], v[80:83]
    v_mfma_f32_16x16x32_bf16 v[60:63], v[144:147], v[96:99], v[60:63]
    v_mfma_f32_16x16x32_bf16 v[64:67], v[148:151], v[96:99], v[64:67]
    v_mfma_f32_16x16x32_bf16 v[68:71], v[152:155], v[96:99], v[68:71]
    s_waitcnt lgkmcnt(2)
    s_barrier
    v_mfma_f32_16x16x32_bf16 v[24:27], a[60:63], v[100:103], v[24:27]
    ds_read_b128 v[112:115], v3 offset:12416
    ds_read_b64 v[122:123], v19 offset:4160
    v_mfma_f32_16x16x32_bf16 v[28:31], a[64:67], v[100:103], v[28:31]
    v_mfma_f32_16x16x32_bf16 v[32:35], a[68:71], v[100:103], v[32:35]
    v_mfma_f32_16x16x32_bf16 v[72:75], a[168:171], v[100:103], v[72:75]
    v_mfma_f32_16x16x32_bf16 v[76:79], a[172:175], v[100:103], v[76:79]
    v_mfma_f32_16x16x32_bf16 v[80:83], a[176:179], v[100:103], v[80:83]
    v_mfma_f32_16x16x32_bf16 v[60:63], v[156:159], v[100:103], v[60:63]
    v_mfma_f32_16x16x32_bf16 v[64:67], v[160:163], v[100:103], v[64:67]
    v_mfma_f32_16x16x32_bf16 v[68:71], v[164:167], v[100:103], v[68:71]
    s_waitcnt lgkmcnt(3)
    v_mfma_f32_16x16x32_bf16 v[24:27], a[72:75], v[104:107], v[24:27]
    ds_read_b128 v[84:87], v1 offset:8192
    v_mfma_f32_16x16x32_bf16 v[28:31], a[76:79], v[104:107], v[28:31]
    v_mfma_f32_16x16x32_bf16 v[32:35], a[80:83], v[104:107], v[32:35]
    v_mfma_f32_16x16x32_bf16 v[72:75], a[180:183], v[104:107], v[72:75]
    v_mfma_f32_16x16x32_bf16 v[76:79], a[184:187], v[104:107], v[76:79]
    v_mfma_f32_16x16x32_bf16 v[80:83], a[188:191], v[104:107], v[80:83]
    v_mfma_f32_16x16x32_bf16 v[60:63], v[168:171], v[104:107], v[60:63]
    v_mfma_f32_16x16x32_bf16 v[64:67], v[172:175], v[104:107], v[64:67]
    v_mfma_f32_16x16x32_bf16 v[68:71], v[176:179], v[104:107], v[68:71]
    s_waitcnt lgkmcnt(3)
    v_mfma_f32_16x16x32_bf16 v[24:27], a[84:87], v[108:111], v[24:27]
    ds_read_b128 v[88:91], v1 offset:8256
    v_mfma_f32_16x16x32_bf16 v[28:31], a[88:91], v[108:111], v[28:31]
    v_mfma_f32_16x16x32_bf16 v[32:35], a[92:95], v[108:111], v[32:35]
    v_mfma_f32_16x16x32_bf16 v[72:75], a[192:195], v[108:111], v[72:75]
    v_mfma_f32_16x16x32_bf16 v[76:79], a[196:199], v[108:111], v[76:79]
    v_mfma_f32_16x16x32_bf16 v[80:83], a[200:203], v[108:111], v[80:83]
    v_mfma_f32_16x16x32_bf16 v[60:63], v[180:183], v[108:111], v[60:63]
    v_mfma_f32_16x16x32_bf16 v[64:67], v[184:187], v[108:111], v[64:67]
    v_mfma_f32_16x16x32_bf16 v[68:71], v[188:191], v[108:111], v[68:71]
    s_waitcnt lgkmcnt(3)
    v_mfma_f32_16x16x32_bf16 v[24:27], a[96:99], v[112:115], v[24:27]
    ds_read_b128 v[92:95], v1 offset:8320
    v_mfma_f32_16x16x32_bf16 v[28:31], a[100:103], v[112:115], v[28:31]
    v_mfma_f32_16x16x32_bf16 v[32:35], a[104:107], v[112:115], v[32:35]
    v_mfma_f32_16x16x32_bf16 v[72:75], a[204:207], v[112:115], v[72:75]
    v_mfma_f32_16x16x32_bf16 v[76:79], a[208:211], v[112:115], v[76:79]
    v_mfma_f32_16x16x32_bf16 v[80:83], a[212:215], v[112:115], v[80:83]
    v_mfma_f32_16x16x32_bf16 v[60:63], v[192:195], v[112:115], v[60:63]
    v_mfma_f32_16x16x32_bf16 v[64:67], v[196:199], v[112:115], v[64:67]
    v_mfma_f32_16x16x32_bf16 v[68:71], v[200:203], v[112:115], v[68:71]
    s_waitcnt lgkmcnt(2)
    v_mfma_f32_16x16x32_bf16 v[24:27], a[108:111], v[84:87], v[24:27]
    ds_read_b128 v[96:99], v2 offset:8192
    v_mfma_f32_16x16x32_bf16 v[28:31], a[112:115], v[84:87], v[28:31]
    v_mfma_f32_16x16x32_bf16 v[32:35], a[116:119], v[84:87], v[32:35]
    v_mfma_f32_16x16x32_bf16 v[72:75], a[216:219], v[84:87], v[72:75]
    v_mfma_f32_16x16x32_bf16 v[76:79], a[220:223], v[84:87], v[76:79]
    v_mfma_f32_16x16x32_bf16 v[80:83], a[224:227], v[84:87], v[80:83]
    v_mfma_f32_16x16x32_bf16 v[44:47], a[8:11], v[84:87], 0
    s_waitcnt lgkmcnt(2)
    v_mfma_f32_16x16x32_bf16 v[24:27], a[120:123], v[88:91], v[24:27]
    ds_read_b128 v[100:103], v2 offset:8256
    v_mfma_f32_16x16x32_bf16 v[28:31], a[124:127], v[88:91], v[28:31]
    v_cvt_pk_bf16_f32 v124, v60, v61
    v_mfma_f32_16x16x32_bf16 v[32:35], a[128:131], v[88:91], v[32:35]
    v_cvt_pk_bf16_f32 v125, v62, v63
    v_mfma_f32_16x16x32_bf16 v[72:75], a[228:231], v[88:91], v[72:75]
    v_cvt_pk_bf16_f32 v126, v64, v65
    v_mfma_f32_16x16x32_bf16 v[76:79], a[232:235], v[88:91], v[76:79]
    v_cvt_pk_bf16_f32 v127, v66, v67
    v_mfma_f32_16x16x32_bf16 v[80:83], a[236:239], v[88:91], v[80:83]
    v_cvt_pk_bf16_f32 v128, v68, v69
    v_mfma_f32_16x16x32_bf16 v[44:47], a[20:23], v[88:91], v[44:47]
    v_cvt_pk_bf16_f32 v129, v70, v71
    s_waitcnt lgkmcnt(2)
    v_mfma_f32_16x16x32_bf16 v[24:27], a[132:135], v[92:95], v[24:27]
    ds_read_b128 v[104:107], v2 offset:8320
    s_add_u32 s43, s42, 129024
    v_mfma_f32_16x16x32_bf16 v[28:31], a[136:139], v[92:95], v[28:31]
    ds_write_b64 v20, v[128:129] offset:6240
    v_mfma_f32_16x16x32_bf16 v[32:35], a[140:143], v[92:95], v[32:35]
    v_permlane16_swap_b32 v124, v126
    v_mfma_f32_16x16x32_bf16 v[72:75], a[240:243], v[92:95], v[72:75]
    v_permlane16_swap_b32 v125, v127
    v_mfma_f32_16x16x32_bf16 v[76:79], a[244:247], v[92:95], v[76:79]
    buffer_store_dwordx4 v[124:127], v14, s[16:19], s43 offen sc1
    v_mfma_f32_16x16x32_bf16 v[80:83], a[248:251], v[92:95], v[80:83]
    s_add_u32 s44, s42, 172032
    v_mfma_f32_16x16x32_bf16 v[44:47], a[32:35], v[92:95], v[44:47]
    buffer_store_dwordx2 v[122:123], v18, s[16:19], s44 offen sc1
    s_waitcnt lgkmcnt(3)
    v_mfma_f32_16x16x32_bf16 v[24:27], a[144:147], v[96:99], v[24:27]
    ds_read_b128 v[108:111], v3 offset:8192
    v_mfma_f32_16x16x32_bf16 v[28:31], a[148:151], v[96:99], v[28:31]
    v_mfma_f32_16x16x32_bf16 v[32:35], a[152:155], v[96:99], v[32:35]
    v_mfma_f32_16x16x32_bf16 v[72:75], v[132:135], v[96:99], v[72:75]
    v_mfma_f32_16x16x32_bf16 v[76:79], v[136:139], v[96:99], v[76:79]
    v_mfma_f32_16x16x32_bf16 v[80:83], v[140:143], v[96:99], v[80:83]
    v_mfma_f32_16x16x32_bf16 v[44:47], a[44:47], v[96:99], v[44:47]
    s_waitcnt lgkmcnt(3)
    v_mfma_f32_16x16x32_bf16 v[24:27], a[156:159], v[100:103], v[24:27]
    ds_read_b128 v[112:115], v3 offset:8256
    v_mfma_f32_16x16x32_bf16 v[28:31], a[160:163], v[100:103], v[28:31]
    v_mfma_f32_16x16x32_bf16 v[32:35], a[164:167], v[100:103], v[32:35]
    v_mfma_f32_16x16x32_bf16 v[72:75], v[144:147], v[100:103], v[72:75]
    v_mfma_f32_16x16x32_bf16 v[76:79], v[148:151], v[100:103], v[76:79]
    v_mfma_f32_16x16x32_bf16 v[80:83], v[152:155], v[100:103], v[80:83]
    v_mfma_f32_16x16x32_bf16 v[44:47], a[56:59], v[100:103], v[44:47]
    s_waitcnt lgkmcnt(3)
    v_mfma_f32_16x16x32_bf16 v[24:27], a[168:171], v[104:107], v[24:27]
    ds_read_b128 v[84:87], v3 offset:8320
    v_mfma_f32_16x16x32_bf16 v[28:31], a[172:175], v[104:107], v[28:31]
    v_mfma_f32_16x16x32_bf16 v[32:35], a[176:179], v[104:107], v[32:35]
    v_mfma_f32_16x16x32_bf16 v[72:75], v[156:159], v[104:107], v[72:75]
    v_mfma_f32_16x16x32_bf16 v[76:79], v[160:163], v[104:107], v[76:79]
    v_mfma_f32_16x16x32_bf16 v[80:83], v[164:167], v[104:107], v[80:83]
    v_mfma_f32_16x16x32_bf16 v[44:47], a[68:71], v[104:107], v[44:47]
    s_waitcnt lgkmcnt(2)
    s_barrier
    v_mfma_f32_16x16x32_bf16 v[24:27], a[180:183], v[108:111], v[24:27]
    ds_read_b128 v[88:91], v1 offset:4096
    ds_read_b64 v[130:131], v19 offset:6240
    v_mfma_f32_16x16x32_bf16 v[28:31], a[184:187], v[108:111], v[28:31]
    v_mfma_f32_16x16x32_bf16 v[32:35], a[188:191], v[108:111], v[32:35]
    v_mfma_f32_16x16x32_bf16 v[72:75], v[168:171], v[108:111], v[72:75]
    v_mfma_f32_16x16x32_bf16 v[76:79], v[172:175], v[108:111], v[76:79]
    v_mfma_f32_16x16x32_bf16 v[80:83], v[176:179], v[108:111], v[80:83]
    v_mfma_f32_16x16x32_bf16 v[44:47], a[80:83], v[108:111], v[44:47]
    s_waitcnt lgkmcnt(3)
    v_mfma_f32_16x16x32_bf16 v[24:27], a[192:195], v[112:115], v[24:27]
    ds_read_b128 v[92:95], v1 offset:4160
    v_mfma_f32_16x16x32_bf16 v[28:31], a[196:199], v[112:115], v[28:31]
    v_mfma_f32_16x16x32_bf16 v[32:35], a[200:203], v[112:115], v[32:35]
    v_mfma_f32_16x16x32_bf16 v[72:75], v[180:183], v[112:115], v[72:75]
    v_mfma_f32_16x16x32_bf16 v[76:79], v[184:187], v[112:115], v[76:79]
    v_mfma_f32_16x16x32_bf16 v[80:83], v[188:191], v[112:115], v[80:83]
    v_mfma_f32_16x16x32_bf16 v[44:47], a[92:95], v[112:115], v[44:47]
    s_waitcnt lgkmcnt(3)
    v_mfma_f32_16x16x32_bf16 v[24:27], a[204:207], v[84:87], v[24:27]
    ds_read_b128 v[96:99], v1 offset:4224
    v_mfma_f32_16x16x32_bf16 v[28:31], a[208:211], v[84:87], v[28:31]
    v_mfma_f32_16x16x32_bf16 v[32:35], a[212:215], v[84:87], v[32:35]
    v_mfma_f32_16x16x32_bf16 v[72:75], v[192:195], v[84:87], v[72:75]
    v_mfma_f32_16x16x32_bf16 v[76:79], v[196:199], v[84:87], v[76:79]
    v_mfma_f32_16x16x32_bf16 v[80:83], v[200:203], v[84:87], v[80:83]
    v_mfma_f32_16x16x32_bf16 v[44:47], a[104:107], v[84:87], v[44:47]
    s_waitcnt lgkmcnt(3)
    v_mfma_f32_16x16x32_bf16 v[24:27], a[216:219], v[88:91], v[24:27]
    ds_read_b128 v[100:103], v2 offset:4096
    v_mfma_f32_16x16x32_bf16 v[28:31], a[220:223], v[88:91], v[28:31]
    v_mfma_f32_16x16x32_bf16 v[32:35], a[224:227], v[88:91], v[32:35]
    v_mfma_f32_16x16x32_bf16 v[44:47], a[116:119], v[88:91], v[44:47]
    s_waitcnt lgkmcnt(2)
    v_mfma_f32_16x16x32_bf16 v[24:27], a[228:231], v[92:95], v[24:27]
    ds_read_b128 v[104:107], v2 offset:4160
    v_mfma_f32_16x16x32_bf16 v[28:31], a[232:235], v[92:95], v[28:31]
    v_mfma_f32_16x16x32_bf16 v[32:35], a[236:239], v[92:95], v[32:35]
    v_mfma_f32_16x16x32_bf16 v[44:47], a[128:131], v[92:95], v[44:47]
    s_waitcnt lgkmcnt(2)
    v_mfma_f32_16x16x32_bf16 v[24:27], a[240:243], v[96:99], v[24:27]
    ds_read_b128 v[108:111], v2 offset:4224
    v_cvt_pk_bf16_f32 v116, v72, v73
    v_mfma_f32_16x16x32_bf16 v[28:31], a[244:247], v[96:99], v[28:31]
    v_cvt_pk_bf16_f32 v117, v74, v75
    v_mfma_f32_16x16x32_bf16 v[32:35], a[248:251], v[96:99], v[32:35]
    v_cvt_pk_bf16_f32 v118, v76, v77
    v_mfma_f32_16x16x32_bf16 v[44:47], a[140:143], v[96:99], v[44:47]
    v_cvt_pk_bf16_f32 v119, v78, v79
    s_waitcnt lgkmcnt(2)
    v_mfma_f32_16x16x32_bf16 v[24:27], v[132:135], v[100:103], v[24:27]
    ds_read_b128 v[112:115], v3 offset:4096
    v_cvt_pk_bf16_f32 v120, v80, v81
    v_mfma_f32_16x16x32_bf16 v[28:31], v[136:139], v[100:103], v[28:31]
    v_cvt_pk_bf16_f32 v121, v82, v83
    v_mfma_f32_16x16x32_bf16 v[32:35], v[140:143], v[100:103], v[32:35]
    s_add_u32 s43, s42, 86016
    v_mfma_f32_16x16x32_bf16 v[44:47], a[152:155], v[100:103], v[44:47]
    ds_write_b64 v20, v[120:121] offset:8320
    s_waitcnt lgkmcnt(3)
    v_mfma_f32_16x16x32_bf16 v[24:27], v[144:147], v[104:107], v[24:27]
    ds_read_b128 v[84:87], v3 offset:4160
    v_permlane16_swap_b32 v116, v118
    v_mfma_f32_16x16x32_bf16 v[28:31], v[148:151], v[104:107], v[28:31]
    v_permlane16_swap_b32 v117, v119
    v_mfma_f32_16x16x32_bf16 v[32:35], v[152:155], v[104:107], v[32:35]
    buffer_store_dwordx4 v[116:119], v14, s[16:19], s43 offen sc1
    v_mfma_f32_16x16x32_bf16 v[44:47], a[164:167], v[104:107], v[44:47]
    s_add_u32 s44, s42, 129024
    s_waitcnt lgkmcnt(3)
    v_mfma_f32_16x16x32_bf16 v[24:27], v[156:159], v[108:111], v[24:27]
    ds_read_b128 v[88:91], v3 offset:4224
    buffer_store_dwordx2 v[130:131], v18, s[16:19], s44 offen sc1
    v_mfma_f32_16x16x32_bf16 v[28:31], v[160:163], v[108:111], v[28:31]
    v_mfma_f32_16x16x32_bf16 v[32:35], v[164:167], v[108:111], v[32:35]
    v_mfma_f32_16x16x32_bf16 v[44:47], a[176:179], v[108:111], v[44:47]
    s_waitcnt lgkmcnt(3)
    v_mfma_f32_16x16x32_bf16 v[24:27], v[168:171], v[112:115], v[24:27]
    ds_read_b128 v[92:95], v1 offset:0
    v_mfma_f32_16x16x32_bf16 v[28:31], v[172:175], v[112:115], v[28:31]
    v_mfma_f32_16x16x32_bf16 v[32:35], v[176:179], v[112:115], v[32:35]
    v_mfma_f32_16x16x32_bf16 v[44:47], a[188:191], v[112:115], v[44:47]
    s_waitcnt lgkmcnt(2)
    s_barrier
    v_mfma_f32_16x16x32_bf16 v[24:27], v[180:183], v[84:87], v[24:27]
    ds_read_b128 v[96:99], v1 offset:64
    ds_read_b64 v[122:123], v19 offset:8320
    v_mfma_f32_16x16x32_bf16 v[28:31], v[184:187], v[84:87], v[28:31]
    v_mfma_f32_16x16x32_bf16 v[32:35], v[188:191], v[84:87], v[32:35]
    v_mfma_f32_16x16x32_bf16 v[44:47], a[200:203], v[84:87], v[44:47]
    s_waitcnt lgkmcnt(3)
    v_mfma_f32_16x16x32_bf16 v[24:27], v[192:195], v[88:91], v[24:27]
    ds_read_b128 v[100:103], v1 offset:128
    v_mfma_f32_16x16x32_bf16 v[28:31], v[196:199], v[88:91], v[28:31]
    v_mfma_f32_16x16x32_bf16 v[32:35], v[200:203], v[88:91], v[32:35]
    v_mfma_f32_16x16x32_bf16 v[44:47], a[212:215], v[88:91], v[44:47]
    s_waitcnt lgkmcnt(3)
    v_mfma_f32_16x16x32_bf16 v[36:39], a[216:219], v[92:95], 0
    ds_read_b128 v[104:107], v2 offset:0
    v_mfma_f32_16x16x32_bf16 v[40:43], a[220:223], v[92:95], 0
    v_mfma_f32_16x16x32_bf16 v[44:47], a[224:227], v[92:95], v[44:47]
    s_waitcnt lgkmcnt(3)
    v_mfma_f32_16x16x32_bf16 v[36:39], a[228:231], v[96:99], v[36:39]
    ds_read_b128 v[108:111], v2 offset:64
    v_mfma_f32_16x16x32_bf16 v[40:43], a[232:235], v[96:99], v[40:43]
    v_mfma_f32_16x16x32_bf16 v[44:47], a[236:239], v[96:99], v[44:47]
    s_waitcnt lgkmcnt(2)
    v_mfma_f32_16x16x32_bf16 v[36:39], a[240:243], v[100:103], v[36:39]
    ds_read_b128 v[112:115], v2 offset:128
    v_mfma_f32_16x16x32_bf16 v[40:43], a[244:247], v[100:103], v[40:43]
    v_mfma_f32_16x16x32_bf16 v[44:47], a[248:251], v[100:103], v[44:47]
    v_cvt_pk_bf16_f32 v124, v24, v25
    s_waitcnt lgkmcnt(2)
    v_mfma_f32_16x16x32_bf16 v[36:39], v[132:135], v[104:107], v[36:39]
    ds_read_b128 v[84:87], v3 offset:0
    v_cvt_pk_bf16_f32 v125, v26, v27
    v_mfma_f32_16x16x32_bf16 v[40:43], v[136:139], v[104:107], v[40:43]
    v_cvt_pk_bf16_f32 v126, v28, v29
    v_mfma_f32_16x16x32_bf16 v[44:47], v[140:143], v[104:107], v[44:47]
    v_cvt_pk_bf16_f32 v127, v30, v31
    s_waitcnt lgkmcnt(2)
    v_mfma_f32_16x16x32_bf16 v[36:39], v[144:147], v[108:111], v[36:39]
    ds_read_b128 v[88:91], v3 offset:64
    v_cvt_pk_bf16_f32 v128, v32, v33
    v_mfma_f32_16x16x32_bf16 v[40:43], v[148:151], v[108:111], v[40:43]
    v_cvt_pk_bf16_f32 v129, v34, v35
    v_mfma_f32_16x16x32_bf16 v[44:47], v[152:155], v[108:111], v[44:47]
    s_add_u32 s43, s42, 43008
    s_waitcnt lgkmcnt(2)
    v_mfma_f32_16x16x32_bf16 v[36:39], v[156:159], v[112:115], v[36:39]
    ds_read_b128 v[92:95], v3 offset:128
    ds_write_b64 v20, v[128:129] offset:10400
    v_mfma_f32_16x16x32_bf16 v[40:43], v[160:163], v[112:115], v[40:43]
    v_permlane16_swap_b32 v124, v126
    v_mfma_f32_16x16x32_bf16 v[44:47], v[164:167], v[112:115], v[44:47]
    v_permlane16_swap_b32 v125, v127
    s_waitcnt lgkmcnt(3)
    v_mfma_f32_16x16x32_bf16 v[36:39], v[168:171], v[84:87], v[36:39]
    ds_read_b128 v[96:99], v1 offset:8192
    buffer_store_dwordx4 v[124:127], v14, s[16:19], s43 offen sc1
    v_mfma_f32_16x16x32_bf16 v[40:43], v[172:175], v[84:87], v[40:43]
    s_add_u32 s44, s42, 86016
    v_mfma_f32_16x16x32_bf16 v[44:47], v[176:179], v[84:87], v[44:47]
    buffer_store_dwordx2 v[122:123], v18, s[16:19], s44 offen sc1
    s_waitcnt lgkmcnt(3)
    v_mfma_f32_16x16x32_bf16 v[36:39], v[180:183], v[88:91], v[36:39]
    ds_read_b128 v[100:103], v1 offset:8256
    v_mfma_f32_16x16x32_bf16 v[40:43], v[184:187], v[88:91], v[40:43]
    v_mfma_f32_16x16x32_bf16 v[44:47], v[188:191], v[88:91], v[44:47]
    s_waitcnt lgkmcnt(3)
    v_mfma_f32_16x16x32_bf16 v[36:39], v[192:195], v[92:95], v[36:39]
    ds_read_b128 v[104:107], v1 offset:8320
    v_mfma_f32_16x16x32_bf16 v[40:43], v[196:199], v[92:95], v[40:43]
    v_mfma_f32_16x16x32_bf16 v[44:47], v[200:203], v[92:95], v[44:47]
    s_waitcnt lgkmcnt(2)
    s_barrier
    v_mfma_f32_16x16x32_bf16 v[36:39], a[0:3], v[96:99], v[36:39]
    ds_read_b128 v[108:111], v2 offset:8192
    v_mfma_f32_16x16x32_bf16 v[40:43], a[4:7], v[96:99], v[40:43]
    s_waitcnt lgkmcnt(2)
    v_mfma_f32_16x16x32_bf16 v[36:39], a[12:15], v[100:103], v[36:39]
    ds_read_b128 v[112:115], v2 offset:8256
    v_mfma_f32_16x16x32_bf16 v[40:43], a[16:19], v[100:103], v[40:43]
    s_waitcnt lgkmcnt(2)
    v_mfma_f32_16x16x32_bf16 v[36:39], a[24:27], v[104:107], v[36:39]
    ds_read_b128 v[84:87], v2 offset:8320
    v_cvt_pk_bf16_f32 v120, v44, v45
    v_mfma_f32_16x16x32_bf16 v[40:43], a[28:31], v[104:107], v[40:43]
    v_cvt_pk_bf16_f32 v121, v46, v47
    s_waitcnt lgkmcnt(2)
    v_mfma_f32_16x16x32_bf16 v[36:39], a[36:39], v[108:111], v[36:39]
    ds_read_b128 v[88:91], v3 offset:8192
    ds_write_b64 v20, v[120:121] offset:12480
    v_mfma_f32_16x16x32_bf16 v[40:43], a[40:43], v[108:111], v[40:43]
    ds_read_b64 v[130:131], v19 offset:10400
    s_waitcnt lgkmcnt(4)
    v_mfma_f32_16x16x32_bf16 v[36:39], a[48:51], v[112:115], v[36:39]
    ds_read_b128 v[92:95], v3 offset:8256
    v_mfma_f32_16x16x32_bf16 v[40:43], a[52:55], v[112:115], v[40:43]
    s_waitcnt lgkmcnt(4)
    v_mfma_f32_16x16x32_bf16 v[36:39], a[60:63], v[84:87], v[36:39]
    ds_read_b128 v[96:99], v3 offset:8320
    v_mfma_f32_16x16x32_bf16 v[40:43], a[64:67], v[84:87], v[40:43]
    s_waitcnt lgkmcnt(4)
    v_mfma_f32_16x16x32_bf16 v[36:39], a[72:75], v[88:91], v[36:39]
    ds_read_b128 v[100:103], v1 offset:4096
    v_mfma_f32_16x16x32_bf16 v[40:43], a[76:79], v[88:91], v[40:43]
    s_waitcnt lgkmcnt(2)
    s_barrier
    v_mfma_f32_16x16x32_bf16 v[36:39], a[84:87], v[92:95], v[36:39]
    ds_read_b128 v[104:107], v1 offset:4160
    s_add_u32 s44, s42, 43008
    v_mfma_f32_16x16x32_bf16 v[40:43], a[88:91], v[92:95], v[40:43]
    buffer_store_dwordx2 v[130:131], v18, s[16:19], s44 offen sc1
    s_waitcnt lgkmcnt(2)
    v_mfma_f32_16x16x32_bf16 v[36:39], a[96:99], v[96:99], v[36:39]
    ds_read_b128 v[108:111], v1 offset:4224
    ds_read_b64 v[120:121], v19 offset:12480
    v_mfma_f32_16x16x32_bf16 v[40:43], a[100:103], v[96:99], v[40:43]
    s_waitcnt lgkmcnt(3)
    v_mfma_f32_16x16x32_bf16 v[36:39], a[108:111], v[100:103], v[36:39]
    ds_read_b128 v[112:115], v2 offset:4096
    v_mfma_f32_16x16x32_bf16 v[40:43], a[112:115], v[100:103], v[40:43]
    s_waitcnt lgkmcnt(3)
    v_mfma_f32_16x16x32_bf16 v[36:39], a[120:123], v[104:107], v[36:39]
    ds_read_b128 v[84:87], v2 offset:4160
    v_mfma_f32_16x16x32_bf16 v[40:43], a[124:127], v[104:107], v[40:43]
    s_waitcnt lgkmcnt(3)
    v_mfma_f32_16x16x32_bf16 v[36:39], a[132:135], v[108:111], v[36:39]
    ds_read_b128 v[88:91], v2 offset:4224
    v_mfma_f32_16x16x32_bf16 v[40:43], a[136:139], v[108:111], v[40:43]
    s_waitcnt lgkmcnt(2)
    v_mfma_f32_16x16x32_bf16 v[36:39], a[144:147], v[112:115], v[36:39]
    ds_read_b128 v[92:95], v3 offset:4096
    s_add_u32 s44, s42, 0
    v_mfma_f32_16x16x32_bf16 v[40:43], a[148:151], v[112:115], v[40:43]
    buffer_store_dwordx2 v[120:121], v18, s[16:19], s44 offen sc1
    s_waitcnt lgkmcnt(2)
    v_mfma_f32_16x16x32_bf16 v[36:39], a[156:159], v[84:87], v[36:39]
    ds_read_b128 v[96:99], v3 offset:4160
    v_mfma_f32_16x16x32_bf16 v[40:43], a[160:163], v[84:87], v[40:43]
    s_waitcnt lgkmcnt(2)
    v_mfma_f32_16x16x32_bf16 v[36:39], a[168:171], v[88:91], v[36:39]
    ds_read_b128 v[100:103], v3 offset:4224
    v_mfma_f32_16x16x32_bf16 v[40:43], a[172:175], v[88:91], v[40:43]
    s_waitcnt lgkmcnt(2)
    v_mfma_f32_16x16x32_bf16 v[36:39], a[180:183], v[92:95], v[36:39]
    v_mfma_f32_16x16x32_bf16 v[40:43], a[184:187], v[92:95], v[40:43]
    s_waitcnt lgkmcnt(1)
    v_mfma_f32_16x16x32_bf16 v[36:39], a[192:195], v[96:99], v[36:39]
    v_mfma_f32_16x16x32_bf16 v[40:43], a[196:199], v[96:99], v[40:43]
    s_waitcnt lgkmcnt(0)
    v_mfma_f32_16x16x32_bf16 v[36:39], a[204:207], v[100:103], v[36:39]
    v_mfma_f32_16x16x32_bf16 v[40:43], a[208:211], v[100:103], v[40:43]
    s_nop 7
    v_cvt_pk_bf16_f32 v116, v36, v37
    v_cvt_pk_bf16_f32 v117, v38, v39
    s_nop 0
    v_cvt_pk_bf16_f32 v118, v40, v41
    v_cvt_pk_bf16_f32 v119, v42, v43
    s_add_u32 s43, s42, 0
    s_nop 0
    v_permlane16_swap_b32 v116, v118
    v_permlane16_swap_b32 v117, v119
    buffer_store_dwordx4 v[116:119], v14, s[16:19], s43 offen sc1
L_end:
    s_endpgm
.if (. - L_pc) < 11264
.fill (11264 - (. - L_pc))/4, 4, 0xBF810000
.endif
.if (L_end - L_pc) > 11328
.error "code larger than prefetch range"
.endif
.section .rodata,"a"
.p2align 6
.amdhsa_kernel standalone__fft_conv__vision_kernel
  .amdhsa_next_free_vgpr 456
  .amdhsa_next_free_sgpr 102
  .amdhsa_accum_offset 204
  .amdhsa_group_segment_fixed_size 0
  .amdhsa_kernarg_size 40
  .amdhsa_user_sgpr_count 2
  .amdhsa_user_sgpr_kernarg_segment_ptr 1
  .amdhsa_system_sgpr_workgroup_id_x 1
.end_amdhsa_kernel
```
